```python
import torch

def _softmax(x, axis=-1):
    return torch.softmax(x, dim=axis)
def _gelu(x):
    return torch.nn.functional.gelu(x, approximate="tanh")
def _silu(x):
    return torch.nn.functional.silu(x)
def _sigmoid(x):
    return torch.sigmoid(x)
def _layernorm(x, axis=-1, eps=1e-5):
    m = x.mean(dim=axis, keepdim=True)
    v = x.var(dim=axis, keepdim=True, unbiased=False)
    return (x - m) / torch.sqrt(v + eps)
def _scatter_add(tgt, idx, src, axis=0):
    return tgt.clone().index_add_(axis, idx, src)
def _segment_sum(src, seg, n):
    out = torch.zeros((n,) + src.shape[1:], dtype=src.dtype)
    return out.index_add_(0, seg, src)
def _pad(x, pw):
    flat = tuple(v for pair in reversed(pw) for v in pair)
    return torch.nn.functional.pad(x, flat)

kernel_name = 'parallel_sum__gqa_block_cached__dense_activation_silu__decode'

def setup_inputs():

    _w = (lambda a: (lambda t: t.to(torch.bfloat16) if t.is_floating_point() else t)(torch.as_tensor(a)))
    def _A_setup():
        B, Sq, D = 1, 1, 576
        Hq, Hkv, Sk, Dh = 32, 16, 65536, 128
        assert Hq % Hkv == 0, (Hq, Hkv)
        return {
            "x": _w((lambda *s: torch.randn(*s, dtype=torch.bfloat16) * 0.05)(B, Sq, D)),
            "k_cache": _w((lambda *s: torch.randn(*s, dtype=torch.bfloat16) * 3.2)(B, Hkv, Sk, Dh)),
            "v_cache": _w((lambda *s: torch.randn(*s, dtype=torch.bfloat16) * 0.8)(B, Hkv, Sk, Dh)),
            "wq": _w((lambda *s: torch.randn(*s, dtype=torch.bfloat16) * 3.2)(D, Hq * Dh) * (D ** -0.5)),
            "wo": _w((lambda *s: torch.randn(*s, dtype=torch.bfloat16) * 0.8)(Hq * Dh, D) * ((Hq * Dh) ** -0.5)),
        }
    _A_in = _A_setup()

    def _B_setup():
        B, S, D, F = 1, 1, 576, 4608
        return {
            "x": _w((lambda *s: torch.randn(*s, dtype=torch.bfloat16) * 0.05)(B, S, D)),
            "w1": _w((lambda *s: torch.randn(*s, dtype=torch.bfloat16) * 3.2)(D, F) * (D ** -0.5)),
            "w2": _w((lambda *s: torch.randn(*s, dtype=torch.bfloat16) * 0.4)(F, D) * (F ** -0.5)),
        }
    _B_in = _B_setup()

    return {
        "A_x": _A_in["x"],
        "A_k_cache": _A_in["k_cache"],
        "A_v_cache": _A_in["v_cache"],
        "A_wq": _A_in["wq"],
        "A_wo": _A_in["wo"],
        "B_x": _B_in["x"],
        "B_w1": _B_in["w1"],
        "B_w2": _B_in["w2"],
    }

def reference(A_x, A_k_cache, A_v_cache, A_wq, A_wo, B_x, B_w1, B_w2):
    def _A_ref(x, k_cache, v_cache, wq, wo):
        B, Sq, D = x.shape
        Hq, Dh = 32, 128
        Hkv = k_cache.shape[1]
        rep = Hq // Hkv
        q = (lambda x, *d: x.permute(*d))((x @ wq).reshape(B, Sq, Hq, Dh), 0, 2, 1, 3)
        k = (lambda x, n, axis: torch.repeat_interleave(x, n, dim=axis))(k_cache, rep, axis=1)
        v = (lambda x, n, axis: torch.repeat_interleave(x, n, dim=axis))(v_cache, rep, axis=1)
        scores = torch.einsum("bhqd,bhkd->bhqk", q, k) * (Dh ** -0.5)
        p = _softmax(scores, axis=-1)
        o = torch.einsum("bhqk,bhkd->bhqd", p, v)
        return (lambda x, *d: x.permute(*d))(o, 0, 2, 1, 3).reshape(B, Sq, Hq * Dh) @ wo

    def _B_ref(x, w1, w2):
        h = torch.einsum("bsd,df->bsf", x, w1)
        h = _silu(h)
        out = torch.einsum("bsf,fd->bsd", h, w2)
        return out

    x = A_x
    xn = _layernorm(x, axis=-1)
    return x + _A_ref(xn, A_k_cache, A_v_cache, A_wq, A_wo) + _B_ref(xn, B_w1, B_w2)
```

```asm
; @launch grid=(256,1,1) block=(576,1,1) lds=163840
.amdgcn_target "amdgcn-amd-amdhsa--gfx950"
.text
.globl parallel_sum__gqa_block_cached__dense_activation_silu__decode_kernel
.p2align 8
.type parallel_sum__gqa_block_cached__dense_activation_silu__decode_kernel,@function
parallel_sum__gqa_block_cached__dense_activation_silu__decode_kernel:
  s_branch L_pad_e
L_e1:
  s_cmp_ge_u32 s2, 256
  s_cbranch_scc1 L_end
  s_load_dwordx16 s[4:19], s[0:1], 0
  s_load_dwordx4 s[20:23], s[0:1], 64
  s_load_dwordx2 s[24:25], s[0:1], 80
  v_lshrrev_b32 v1, 6, v0
  s_lshr_b32 s27, s2, 4
  s_and_b32 s28, s2, 15
  v_readfirstlane_b32 s26, v1
  v_and_b32 v1, 63, v0
  s_cmp_ge_u32 s26, 8
  s_cbranch_scc1 L_helper
  s_cmp_lt_u32 s26, 4
  s_cbranch_scc1 L_cons0
  s_sub_u32 s29, s26, 4
  s_mul_i32 s44, s27, 512
  s_and_b32 s41, s28, 7
  s_lshl_b32 s41, s41, 4
  s_lshr_b32 s49, s28, 3
  s_lshl_b32 s49, s49, 3
  s_add_u32 s41, s41, s49
  s_add_u32 s49, s41, s44
  s_add_u32 s41, s49, s29
  s_and_b32 s41, s41, 4095
  s_and_b32 s50, s41, 15
  s_mul_i32 s50, s50, 3840
  s_lshl_b32 s41, s41, 12
  s_sub_u32 s41, s41, s50
  s_lshl_b32 s40, s27, 24
  s_add_u32 s41, s41, s40
  s_lshl_b32 s38, s29, 15
  s_mov_b32 m0, s38
  v_lshrrev_b32 v2, 4, v1
  v_and_b32 v3, 15, v1
  v_lshlrev_b32 v4, 1, v2
  v_xor_b32 v3, v3, v4
  v_lshlrev_b32 v3, 4, v3
  v_lshl_add_u32 v24, v2, 12, v3
  v_xor_b32 v25, 128, v24
  v_add_u32 v26, 30720, v24
  v_add_u32 v25, 15360, v25
  s_waitcnt lgkmcnt(0)
  s_add_u32 s36, s6, s41
  s_addc_u32 s37, s7, 0
  global_load_lds_dwordx4 v24, s[36:37] offset:0 nt
  global_load_lds_dwordx4 v25, s[36:37] offset:1024 nt
  s_branch L_pad_e_skip
L_pad_e:
  s_branch L_e1
L_pad_e_skip:
  global_load_lds_dwordx4 v26, s[36:37] offset:2048 nt
  v_add_u32 v27, 30720, v25
  global_load_lds_dwordx4 v27, s[36:37] offset:3072 nt
  s_add_u32 s30, s6, s40
  s_addc_u32 s31, s7, 0
  s_add_u32 s32, s8, s40
  s_addc_u32 s33, s9, 0
  s_sub_u32 s40, s41, s40
  s_add_u32 s44, s44, 3584
  s_lshl_b32 s41, s29, 2
  s_add_u32 s41, s41, 151552
  v_mov_b32 v8, s41
  v_mov_b32 v14, 151552
  v_mov_b32 v16, 1
  s_mov_b32 s35, 0
  s_mov_b32 s47, 0
  v_mov_b32 v10, 0
  v_mov_b32 v12, 151616
  v_mov_b32 v20, 0
  v_mov_b32 v21, 0
  v_mov_b32 v22, 0
  v_mov_b32 v23, 0
  s_setprio 2
  s_barrier
  s_branch L_ld_first_v
L_cons0:
  v_lshlrev_b32 v2, 2, v1
  v_add_u32 v2, 151552, v2
  v_mov_b32 v3, 0
  ds_write_b32 v2, v3
  s_lshl_b32 s40, s26, 10
  s_add_u32 s40, s40, 156928
  v_lshlrev_b32 v2, 4, v1
  v_add_u32 v2, s40, v2
  v_mov_b32 v4, 0
  v_mov_b32 v5, 0
  v_mov_b32 v6, 0
  v_mov_b32 v7, 0
  ds_write_b128 v2, v[4:7]
  s_waitcnt lgkmcnt(0)
  s_barrier
  s_branch L_cons1
L_ld_loop:
  s_waitcnt lgkmcnt(0)
  v_readfirstlane_b32 s39, v10
  s_lshr_b32 s41, s46, 3
  s_and_b32 s43, s46, 7
  s_cmp_ge_u32 s41, 28
  s_cbranch_scc1 L_ld_sh0
  s_lshl_b32 s41, s41, 7
  s_add_u32 s41, s41, s49
  s_add_u32 s41, s41, s43
  s_and_b32 s41, s41, 4095
L_ld_adr0:
  s_add_u32 s40, s39, 3
  s_cmp_lt_u32 s40, s35
  s_cbranch_scc1 L_ld_sp0
L_ld_ok0:
  s_and_b32 s50, s41, 15
  s_mul_i32 s50, s50, 3840
  s_lshl_b32 s40, s41, 12
  s_sub_u32 s40, s40, s50
  s_cmp_lg_u32 s47, 0
  s_cbranch_scc1 L_ld_fast0
  s_add_u32 s36, s30, s40
  s_addc_u32 s37, s31, 0
  s_add_u32 m0, s38, 0
  s_waitcnt vmcnt(4)
  global_load_lds_dwordx4 v24, s[36:37] offset:0 nt
  s_waitcnt vmcnt(4)
  global_load_lds_dwordx4 v25, s[36:37] offset:1024 nt
  s_waitcnt vmcnt(4)
  global_load_lds_dwordx4 v26, s[36:37] offset:2048 nt
  s_waitcnt vmcnt(4)
  global_load_lds_dwordx4 v27, s[36:37] offset:3072 nt
L_ld_first_v:
  s_add_u32 s36, s32, s40
  s_addc_u32 s37, s33, 0
  s_add_u32 m0, s38, 4096
  s_waitcnt vmcnt(4)
  v_mov_b32 v9, s35
  s_mov_b64 exec, 1
  ds_write_b32 v8, v9
  s_mov_b64 exec, -1
  global_load_lds_dwordx4 v24, s[36:37] offset:0 nt
  s_mov_b64 exec, 1
  ds_add_rtn_u32 v15, v14, v16 offset:52
  s_mov_b64 exec, -1
  s_waitcnt vmcnt(4)
  global_load_lds_dwordx4 v25, s[36:37] offset:1024 nt
  s_waitcnt vmcnt(4)
  global_load_lds_dwordx4 v26, s[36:37] offset:2048 nt
  s_waitcnt lgkmcnt(0)
  v_readfirstlane_b32 s46, v15
  ds_read_b32 v10, v8 offset:16
  s_lshl_b32 s48, s46, 2
  s_add_u32 s48, s48, 156048
  v_mov_b32 v12, s48
  ds_read_b32 v11, v12
  s_add_u32 s46, s46, 4
  s_waitcnt vmcnt(4)
  global_load_lds_dwordx4 v27, s[36:37] offset:3072 nt
L_ld_join0:
  s_add_u32 s35, s35, 1
  s_waitcnt lgkmcnt(0)
  v_readfirstlane_b32 s39, v10
  s_lshr_b32 s41, s46, 3
  s_and_b32 s43, s46, 7
  s_cmp_ge_u32 s41, 28
  s_cbranch_scc1 L_ld_sh1
  s_lshl_b32 s41, s41, 7
  s_add_u32 s41, s41, s49
  s_add_u32 s41, s41, s43
  s_and_b32 s41, s41, 4095
L_ld_adr1:
  s_add_u32 s40, s39, 3
  s_cmp_lt_u32 s40, s35
  s_cbranch_scc1 L_ld_sp1
L_ld_ok1:
  s_and_b32 s50, s41, 15
  s_mul_i32 s50, s50, 3840
  s_lshl_b32 s40, s41, 12
  s_sub_u32 s40, s40, s50
  s_cmp_lg_u32 s47, 0
  s_cbranch_scc1 L_ld_fast1
  s_add_u32 s36, s30, s40
  s_addc_u32 s37, s31, 0
  s_add_u32 m0, s38, 8192
  s_waitcnt vmcnt(4)
  global_load_lds_dwordx4 v24, s[36:37] offset:0 nt
  s_waitcnt vmcnt(4)
  global_load_lds_dwordx4 v25, s[36:37] offset:1024 nt
  s_waitcnt vmcnt(4)
  global_load_lds_dwordx4 v26, s[36:37] offset:2048 nt
  s_waitcnt vmcnt(4)
  global_load_lds_dwordx4 v27, s[36:37] offset:3072 nt
  s_add_u32 s36, s32, s40
  s_addc_u32 s37, s33, 0
  s_add_u32 m0, s38, 12288
  s_waitcnt vmcnt(4)
  v_mov_b32 v9, s35
  s_mov_b64 exec, 1
  ds_write_b32 v8, v9
  s_mov_b64 exec, -1
  global_load_lds_dwordx4 v24, s[36:37] offset:0 nt
  s_mov_b64 exec, 1
  ds_add_rtn_u32 v15, v14, v16 offset:52
  s_mov_b64 exec, -1
  s_waitcnt vmcnt(4)
  global_load_lds_dwordx4 v25, s[36:37] offset:1024 nt
  s_waitcnt vmcnt(4)
  global_load_lds_dwordx4 v26, s[36:37] offset:2048 nt
  s_waitcnt lgkmcnt(0)
  v_readfirstlane_b32 s46, v15
  ds_read_b32 v10, v8 offset:16
  s_lshl_b32 s48, s46, 2
  s_add_u32 s48, s48, 156048
  v_mov_b32 v12, s48
  ds_read_b32 v11, v12
  s_add_u32 s46, s46, 4
  s_waitcnt vmcnt(4)
  global_load_lds_dwordx4 v27, s[36:37] offset:3072 nt
L_ld_join1:
  s_add_u32 s35, s35, 1
  s_waitcnt lgkmcnt(0)
  v_readfirstlane_b32 s39, v10
  s_lshr_b32 s41, s46, 3
  s_and_b32 s43, s46, 7
  s_cmp_ge_u32 s41, 28
  s_cbranch_scc1 L_ld_sh2
  s_lshl_b32 s41, s41, 7
  s_add_u32 s41, s41, s49
  s_add_u32 s41, s41, s43
  s_and_b32 s41, s41, 4095
L_ld_adr2:
  s_add_u32 s40, s39, 3
  s_cmp_lt_u32 s40, s35
  s_cbranch_scc1 L_ld_sp2
L_ld_ok2:
  s_and_b32 s50, s41, 15
  s_mul_i32 s50, s50, 3840
  s_lshl_b32 s40, s41, 12
  s_sub_u32 s40, s40, s50
  s_cmp_lg_u32 s47, 0
  s_cbranch_scc1 L_ld_fast2
  s_add_u32 s36, s30, s40
  s_addc_u32 s37, s31, 0
  s_add_u32 m0, s38, 16384
  s_waitcnt vmcnt(4)
  global_load_lds_dwordx4 v24, s[36:37] offset:0 nt
  s_waitcnt vmcnt(4)
  global_load_lds_dwordx4 v25, s[36:37] offset:1024 nt
  s_waitcnt vmcnt(4)
  global_load_lds_dwordx4 v26, s[36:37] offset:2048 nt
  s_waitcnt vmcnt(4)
  global_load_lds_dwordx4 v27, s[36:37] offset:3072 nt
  s_add_u32 s36, s32, s40
  s_addc_u32 s37, s33, 0
  s_add_u32 m0, s38, 20480
  s_waitcnt vmcnt(4)
  v_mov_b32 v9, s35
  s_mov_b64 exec, 1
  ds_write_b32 v8, v9
  s_mov_b64 exec, -1
  global_load_lds_dwordx4 v24, s[36:37] offset:0 nt
  s_mov_b64 exec, 1
  ds_add_rtn_u32 v15, v14, v16 offset:52
  s_mov_b64 exec, -1
  s_waitcnt vmcnt(4)
  global_load_lds_dwordx4 v25, s[36:37] offset:1024 nt
  s_waitcnt vmcnt(4)
  global_load_lds_dwordx4 v26, s[36:37] offset:2048 nt
  s_waitcnt lgkmcnt(0)
  v_readfirstlane_b32 s46, v15
  ds_read_b32 v10, v8 offset:16
  s_lshl_b32 s48, s46, 2
  s_add_u32 s48, s48, 156048
  v_mov_b32 v12, s48
  ds_read_b32 v11, v12
  s_add_u32 s46, s46, 4
  s_waitcnt vmcnt(4)
  global_load_lds_dwordx4 v27, s[36:37] offset:3072 nt
L_ld_join2:
  s_add_u32 s35, s35, 1
  s_waitcnt lgkmcnt(0)
  v_readfirstlane_b32 s39, v10
  s_lshr_b32 s41, s46, 3
  s_and_b32 s43, s46, 7
  s_cmp_ge_u32 s41, 28
  s_cbranch_scc1 L_ld_sh3
  s_lshl_b32 s41, s41, 7
  s_add_u32 s41, s41, s49
  s_add_u32 s41, s41, s43
  s_and_b32 s41, s41, 4095
L_ld_adr3:
  s_add_u32 s40, s39, 3
  s_cmp_lt_u32 s40, s35
  s_cbranch_scc1 L_ld_sp3
L_ld_ok3:
  s_and_b32 s50, s41, 15
  s_mul_i32 s50, s50, 3840
  s_lshl_b32 s40, s41, 12
  s_sub_u32 s40, s40, s50
  s_cmp_lg_u32 s47, 0
  s_cbranch_scc1 L_ld_fast3
  s_add_u32 s36, s30, s40
  s_addc_u32 s37, s31, 0
  s_add_u32 m0, s38, 24576
  s_waitcnt vmcnt(4)
  global_load_lds_dwordx4 v24, s[36:37] offset:0 nt
  s_waitcnt vmcnt(4)
  global_load_lds_dwordx4 v25, s[36:37] offset:1024 nt
  s_waitcnt vmcnt(4)
  global_load_lds_dwordx4 v26, s[36:37] offset:2048 nt
  s_waitcnt vmcnt(4)
  global_load_lds_dwordx4 v27, s[36:37] offset:3072 nt
  s_add_u32 s36, s32, s40
  s_addc_u32 s37, s33, 0
  s_add_u32 m0, s38, 28672
  s_waitcnt vmcnt(4)
  v_mov_b32 v9, s35
  s_mov_b64 exec, 1
  ds_write_b32 v8, v9
  s_mov_b64 exec, -1
  global_load_lds_dwordx4 v24, s[36:37] offset:0 nt
  s_mov_b64 exec, 1
  ds_add_rtn_u32 v15, v14, v16 offset:52
  s_mov_b64 exec, -1
  s_waitcnt vmcnt(4)
  global_load_lds_dwordx4 v25, s[36:37] offset:1024 nt
  s_waitcnt vmcnt(4)
  global_load_lds_dwordx4 v26, s[36:37] offset:2048 nt
  s_waitcnt lgkmcnt(0)
  v_readfirstlane_b32 s46, v15
  ds_read_b32 v10, v8 offset:16
  s_lshl_b32 s48, s46, 2
  s_add_u32 s48, s48, 156048
  v_mov_b32 v12, s48
  ds_read_b32 v11, v12
  s_add_u32 s46, s46, 4
  s_waitcnt vmcnt(4)
  global_load_lds_dwordx4 v27, s[36:37] offset:3072 nt
L_ld_join3:
  s_add_u32 s35, s35, 1
  s_branch L_ld_loop
L_ld_sp0:
  s_waitcnt vmcnt(0)
  v_mov_b32 v9, s35
  s_mov_b64 exec, 1
  ds_write_b32 v8, v9
  s_mov_b64 exec, -1
  s_mov_b32 s42, 262144
L_ld_spl0:
  ds_read_b32 v10, v8 offset:16
  s_waitcnt lgkmcnt(0)
  v_readfirstlane_b32 s39, v10
  s_add_u32 s40, s39, 3
  s_cmp_ge_u32 s40, s35
  s_cbranch_scc1 L_ld_ok0
  s_sleep 1
  s_sub_u32 s42, s42, 1
  s_cmp_lg_u32 s42, 0
  s_cbranch_scc1 L_ld_spl0
  s_branch L_ld_ok0
L_ld_sp1:
  s_waitcnt vmcnt(0)
  s_branch L_pad_0_skip
L_pad_0:
  s_branch L_pad_1
L_pad_0_skip:
  v_mov_b32 v9, s35
  s_mov_b64 exec, 1
  ds_write_b32 v8, v9
  s_mov_b64 exec, -1
  s_mov_b32 s42, 262144
L_ld_spl1:
  ds_read_b32 v10, v8 offset:16
  s_waitcnt lgkmcnt(0)
  v_readfirstlane_b32 s39, v10
  s_add_u32 s40, s39, 3
  s_cmp_ge_u32 s40, s35
  s_cbranch_scc1 L_ld_ok1
  s_sleep 1
  s_sub_u32 s42, s42, 1
  s_cmp_lg_u32 s42, 0
  s_cbranch_scc1 L_ld_spl1
  s_branch L_ld_ok1
L_ld_sp2:
  s_waitcnt vmcnt(0)
  v_mov_b32 v9, s35
  s_mov_b64 exec, 1
  ds_write_b32 v8, v9
  s_mov_b64 exec, -1
  s_mov_b32 s42, 262144
L_ld_spl2:
  ds_read_b32 v10, v8 offset:16
  s_waitcnt lgkmcnt(0)
  v_readfirstlane_b32 s39, v10
  s_add_u32 s40, s39, 3
  s_cmp_ge_u32 s40, s35
  s_cbranch_scc1 L_ld_ok2
  s_sleep 1
  s_sub_u32 s42, s42, 1
  s_cmp_lg_u32 s42, 0
  s_cbranch_scc1 L_ld_spl2
  s_branch L_ld_ok2
L_ld_sp3:
  s_waitcnt vmcnt(0)
  v_mov_b32 v9, s35
  s_mov_b64 exec, 1
  ds_write_b32 v8, v9
  s_mov_b64 exec, -1
  s_mov_b32 s42, 262144
L_ld_spl3:
  ds_read_b32 v10, v8 offset:16
  s_waitcnt lgkmcnt(0)
  v_readfirstlane_b32 s39, v10
  s_add_u32 s40, s39, 3
  s_cmp_ge_u32 s40, s35
  s_cbranch_scc1 L_ld_ok3
  s_sleep 1
  s_sub_u32 s42, s42, 1
  s_cmp_lg_u32 s42, 0
  s_cbranch_scc1 L_ld_spl3
  s_branch L_ld_ok3
L_ld_sh0:
  v_readfirstlane_b32 s45, v11
  s_cmp_lg_u32 s45, 0
  s_cbranch_scc1 L_ld_rdy0
  ds_read_b32 v11, v12
  s_waitcnt lgkmcnt(0)
  v_readfirstlane_b32 s45, v11
  s_cmp_lg_u32 s45, 0
  s_cbranch_scc1 L_ld_rdy0
  s_waitcnt vmcnt(0)
  v_mov_b32 v9, s35
  s_mov_b64 exec, 1
  ds_write_b32 v8, v9
  s_mov_b64 exec, -1
  s_mov_b32 s42, 262144
L_ld_shspin0:
  ds_read_b32 v11, v12
  s_waitcnt lgkmcnt(0)
  v_readfirstlane_b32 s45, v11
  s_cmp_lg_u32 s45, 0
  s_cbranch_scc1 L_ld_rdy0
  s_sleep 1
  s_sub_u32 s42, s42, 1
  s_cmp_lg_u32 s42, 0
  s_cbranch_scc1 L_ld_shspin0
  s_branch L_ld_end
L_ld_rdy0:
  s_cmp_lt_i32 s45, 0
  s_cbranch_scc1 L_ld_end
  s_bfe_u32 s47, s45, 0x1001e
  s_sub_u32 s41, s45, 1
  s_and_b32 s41, s41, 4095
  s_branch L_ld_adr0
L_ld_sh1:
  v_readfirstlane_b32 s45, v11
  s_cmp_lg_u32 s45, 0
  s_cbranch_scc1 L_ld_rdy1
  ds_read_b32 v11, v12
  s_waitcnt lgkmcnt(0)
  v_readfirstlane_b32 s45, v11
  s_cmp_lg_u32 s45, 0
  s_cbranch_scc1 L_ld_rdy1
  s_waitcnt vmcnt(0)
  v_mov_b32 v9, s35
  s_mov_b64 exec, 1
  ds_write_b32 v8, v9
  s_mov_b64 exec, -1
  s_mov_b32 s42, 262144
L_ld_shspin1:
  ds_read_b32 v11, v12
  s_waitcnt lgkmcnt(0)
  v_readfirstlane_b32 s45, v11
  s_cmp_lg_u32 s45, 0
  s_cbranch_scc1 L_ld_rdy1
  s_sleep 1
  s_sub_u32 s42, s42, 1
  s_cmp_lg_u32 s42, 0
  s_cbranch_scc1 L_ld_shspin1
  s_branch L_ld_end
L_ld_rdy1:
  s_cmp_lt_i32 s45, 0
  s_cbranch_scc1 L_ld_end
  s_bfe_u32 s47, s45, 0x1001e
  s_sub_u32 s41, s45, 1
  s_and_b32 s41, s41, 4095
  s_branch L_ld_adr1
L_ld_sh2:
  v_readfirstlane_b32 s45, v11
  s_cmp_lg_u32 s45, 0
  s_cbranch_scc1 L_ld_rdy2
  ds_read_b32 v11, v12
  s_waitcnt lgkmcnt(0)
  v_readfirstlane_b32 s45, v11
  s_cmp_lg_u32 s45, 0
  s_cbranch_scc1 L_ld_rdy2
  s_waitcnt vmcnt(0)
  v_mov_b32 v9, s35
  s_mov_b64 exec, 1
  ds_write_b32 v8, v9
  s_mov_b64 exec, -1
  s_mov_b32 s42, 262144
L_ld_shspin2:
  ds_read_b32 v11, v12
  s_waitcnt lgkmcnt(0)
  v_readfirstlane_b32 s45, v11
  s_cmp_lg_u32 s45, 0
  s_cbranch_scc1 L_ld_rdy2
  s_sleep 1
  s_sub_u32 s42, s42, 1
  s_cmp_lg_u32 s42, 0
  s_cbranch_scc1 L_ld_shspin2
  s_branch L_ld_end
L_ld_rdy2:
  s_cmp_lt_i32 s45, 0
  s_cbranch_scc1 L_ld_end
  s_bfe_u32 s47, s45, 0x1001e
  s_sub_u32 s41, s45, 1
  s_and_b32 s41, s41, 4095
  s_branch L_ld_adr2
L_ld_sh3:
  v_readfirstlane_b32 s45, v11
  s_cmp_lg_u32 s45, 0
  s_cbranch_scc1 L_ld_rdy3
  ds_read_b32 v11, v12
  s_waitcnt lgkmcnt(0)
  v_readfirstlane_b32 s45, v11
  s_cmp_lg_u32 s45, 0
  s_cbranch_scc1 L_ld_rdy3
  s_waitcnt vmcnt(0)
  v_mov_b32 v9, s35
  s_mov_b64 exec, 1
  ds_write_b32 v8, v9
  s_mov_b64 exec, -1
  s_mov_b32 s42, 262144
L_ld_shspin3:
  ds_read_b32 v11, v12
  s_waitcnt lgkmcnt(0)
  v_readfirstlane_b32 s45, v11
  s_cmp_lg_u32 s45, 0
  s_cbranch_scc1 L_ld_rdy3
  s_sleep 1
  s_sub_u32 s42, s42, 1
  s_cmp_lg_u32 s42, 0
  s_cbranch_scc1 L_ld_shspin3
  s_branch L_ld_end
L_ld_rdy3:
  s_cmp_lt_i32 s45, 0
  s_cbranch_scc1 L_ld_end
  s_bfe_u32 s47, s45, 0x1001e
  s_sub_u32 s41, s45, 1
  s_and_b32 s41, s41, 4095
  s_branch L_ld_adr3
L_ld_fast0:
  s_add_u32 s36, s30, s40
  s_addc_u32 s37, s31, 0
  s_add_u32 m0, s38, 0
  s_waitcnt vmcnt(11)
  global_load_lds_dwordx4 v24, s[36:37] offset:0 nt
  s_waitcnt vmcnt(11)
  global_load_lds_dwordx4 v25, s[36:37] offset:1024 nt
  s_waitcnt vmcnt(11)
  global_load_lds_dwordx4 v26, s[36:37] offset:2048 nt
  s_waitcnt vmcnt(11)
  s_cmp_lt_u32 s35, 1
  s_cbranch_scc1 L_ld_np_5
  s_sub_u32 s43, s35, 1
  v_mov_b32 v9, s43
  s_mov_b64 exec, 1
  ds_write_b32 v8, v9
  s_mov_b64 exec, -1
L_ld_np_5:
  global_load_lds_dwordx4 v27, s[36:37] offset:3072 nt
  s_add_u32 s36, s32, s40
  s_addc_u32 s37, s33, 0
  s_add_u32 m0, s38, 4096
  s_waitcnt vmcnt(11)
  global_load_lds_dwordx4 v24, s[36:37] offset:0 nt
  s_mov_b64 exec, 1
  ds_add_rtn_u32 v15, v14, v16 offset:52
  s_mov_b64 exec, -1
  s_waitcnt vmcnt(11)
  global_load_lds_dwordx4 v25, s[36:37] offset:1024 nt
  s_waitcnt vmcnt(11)
  global_load_lds_dwordx4 v26, s[36:37] offset:2048 nt
  s_waitcnt lgkmcnt(0)
  v_readfirstlane_b32 s46, v15
  ds_read_b32 v10, v8 offset:16
  s_lshl_b32 s48, s46, 2
  s_add_u32 s48, s48, 156048
  v_mov_b32 v12, s48
  ds_read_b32 v11, v12
  s_add_u32 s46, s46, 4
  s_waitcnt vmcnt(11)
  global_load_lds_dwordx4 v27, s[36:37] offset:3072 nt
  s_branch L_ld_join0
L_ld_fast1:
  s_add_u32 s36, s30, s40
  s_addc_u32 s37, s31, 0
  s_add_u32 m0, s38, 8192
  s_waitcnt vmcnt(11)
  global_load_lds_dwordx4 v24, s[36:37] offset:0 nt
  s_waitcnt vmcnt(11)
  global_load_lds_dwordx4 v25, s[36:37] offset:1024 nt
  s_waitcnt vmcnt(11)
  global_load_lds_dwordx4 v26, s[36:37] offset:2048 nt
  s_waitcnt vmcnt(11)
  s_cmp_lt_u32 s35, 1
  s_cbranch_scc1 L_ld_np_6
  s_sub_u32 s43, s35, 1
  v_mov_b32 v9, s43
  s_mov_b64 exec, 1
  ds_write_b32 v8, v9
  s_mov_b64 exec, -1
L_ld_np_6:
  global_load_lds_dwordx4 v27, s[36:37] offset:3072 nt
  s_add_u32 s36, s32, s40
  s_addc_u32 s37, s33, 0
  s_add_u32 m0, s38, 12288
  s_waitcnt vmcnt(11)
  global_load_lds_dwordx4 v24, s[36:37] offset:0 nt
  s_mov_b64 exec, 1
  ds_add_rtn_u32 v15, v14, v16 offset:52
  s_mov_b64 exec, -1
  s_waitcnt vmcnt(11)
  global_load_lds_dwordx4 v25, s[36:37] offset:1024 nt
  s_waitcnt vmcnt(11)
  global_load_lds_dwordx4 v26, s[36:37] offset:2048 nt
  s_waitcnt lgkmcnt(0)
  v_readfirstlane_b32 s46, v15
  ds_read_b32 v10, v8 offset:16
  s_lshl_b32 s48, s46, 2
  s_add_u32 s48, s48, 156048
  v_mov_b32 v12, s48
  ds_read_b32 v11, v12
  s_add_u32 s46, s46, 4
  s_waitcnt vmcnt(11)
  global_load_lds_dwordx4 v27, s[36:37] offset:3072 nt
  s_branch L_ld_join1
L_ld_fast2:
  s_add_u32 s36, s30, s40
  s_addc_u32 s37, s31, 0
  s_add_u32 m0, s38, 16384
  s_branch L_pad_1_skip
L_pad_1:
  s_branch L_pad_4
L_pad_1_skip:
  s_waitcnt vmcnt(11)
  global_load_lds_dwordx4 v24, s[36:37] offset:0 nt
  s_waitcnt vmcnt(11)
  global_load_lds_dwordx4 v25, s[36:37] offset:1024 nt
  s_waitcnt vmcnt(11)
  global_load_lds_dwordx4 v26, s[36:37] offset:2048 nt
  s_waitcnt vmcnt(11)
  s_cmp_lt_u32 s35, 1
  s_cbranch_scc1 L_ld_np_7
  s_sub_u32 s43, s35, 1
  v_mov_b32 v9, s43
  s_mov_b64 exec, 1
  ds_write_b32 v8, v9
  s_mov_b64 exec, -1
L_ld_np_7:
  global_load_lds_dwordx4 v27, s[36:37] offset:3072 nt
  s_add_u32 s36, s32, s40
  s_addc_u32 s37, s33, 0
  s_add_u32 m0, s38, 20480
  s_waitcnt vmcnt(11)
  global_load_lds_dwordx4 v24, s[36:37] offset:0 nt
  s_mov_b64 exec, 1
  ds_add_rtn_u32 v15, v14, v16 offset:52
  s_mov_b64 exec, -1
  s_waitcnt vmcnt(11)
  global_load_lds_dwordx4 v25, s[36:37] offset:1024 nt
  s_waitcnt vmcnt(11)
  global_load_lds_dwordx4 v26, s[36:37] offset:2048 nt
  s_waitcnt lgkmcnt(0)
  v_readfirstlane_b32 s46, v15
  ds_read_b32 v10, v8 offset:16
  s_lshl_b32 s48, s46, 2
  s_add_u32 s48, s48, 156048
  v_mov_b32 v12, s48
  ds_read_b32 v11, v12
  s_add_u32 s46, s46, 4
  s_waitcnt vmcnt(11)
  global_load_lds_dwordx4 v27, s[36:37] offset:3072 nt
  s_branch L_ld_join2
L_ld_fast3:
  s_add_u32 s36, s30, s40
  s_addc_u32 s37, s31, 0
  s_add_u32 m0, s38, 24576
  s_waitcnt vmcnt(11)
  global_load_lds_dwordx4 v24, s[36:37] offset:0 nt
  s_waitcnt vmcnt(11)
  global_load_lds_dwordx4 v25, s[36:37] offset:1024 nt
  s_waitcnt vmcnt(11)
  global_load_lds_dwordx4 v26, s[36:37] offset:2048 nt
  s_waitcnt vmcnt(11)
  s_cmp_lt_u32 s35, 1
  s_cbranch_scc1 L_ld_np_8
  s_sub_u32 s43, s35, 1
  v_mov_b32 v9, s43
  s_mov_b64 exec, 1
  ds_write_b32 v8, v9
  s_mov_b64 exec, -1
L_ld_np_8:
  global_load_lds_dwordx4 v27, s[36:37] offset:3072 nt
  s_add_u32 s36, s32, s40
  s_addc_u32 s37, s33, 0
  s_add_u32 m0, s38, 28672
  s_waitcnt vmcnt(11)
  global_load_lds_dwordx4 v24, s[36:37] offset:0 nt
  s_mov_b64 exec, 1
  ds_add_rtn_u32 v15, v14, v16 offset:52
  s_mov_b64 exec, -1
  s_waitcnt vmcnt(11)
  global_load_lds_dwordx4 v25, s[36:37] offset:1024 nt
  s_waitcnt vmcnt(11)
  global_load_lds_dwordx4 v26, s[36:37] offset:2048 nt
  s_waitcnt lgkmcnt(0)
  v_readfirstlane_b32 s46, v15
  ds_read_b32 v10, v8 offset:16
  s_lshl_b32 s48, s46, 2
  s_add_u32 s48, s48, 156048
  v_mov_b32 v12, s48
  ds_read_b32 v11, v12
  s_add_u32 s46, s46, 4
  s_waitcnt vmcnt(11)
  global_load_lds_dwordx4 v27, s[36:37] offset:3072 nt
  s_branch L_ld_join3
L_ld_end:
  s_waitcnt vmcnt(8)
  s_sub_i32 s43, s35, 1
  s_max_i32 s43, s43, 0
  v_mov_b32 v9, s43
  s_mov_b64 exec, 1
  ds_write_b32 v8, v9
  s_mov_b64 exec, -1
  s_waitcnt vmcnt(0)
  s_or_b32 s43, s35, 0x80000000
  v_mov_b32 v9, s43
  s_mov_b64 exec, 1
  ds_write_b32 v8, v9
  s_mov_b64 exec, -1
  s_waitcnt lgkmcnt(0)
  s_endpgm
  .balignl 256, 0xbf810000
  .fill 48, 4, 0xbf810000
L_helper:
  s_memrealtime s[98:99]
  s_setprio 3
  v_mov_b32 v2, 0
  s_mov_b32 s54, 1152
  s_mov_b32 s55, 0x00020000
  v_lshlrev_b32 v4, 1, v1
  s_lshr_b32 s50, s2, 2
  s_and_b32 s51, s2, 3
  s_lshl_b32 s40, s50, 7
  s_mul_i32 s58, s51, 1179648
  s_add_u32 s40, s40, s58
  v_lshrrev_b32 v5, 3, v1
  v_and_b32 v6, 7, v1
  v_lshrrev_b32 v7, 4, v1
  v_lshlrev_b32 v7, 1, v7
  v_xor_b32 v6, v6, v7
  v_lshlrev_b32 v6, 4, v6
  v_lshl_add_u32 v22, v5, 13, v6
  v_mul_u32_u24 v25, 9216, v5
  v_add_u32 v25, v25, v6
  v_lshlrev_b32 v23, 4, v1
  s_waitcnt lgkmcnt(0)
  s_mov_b32 s52, s4
  s_mov_b32 s53, s5
  buffer_load_ushort v30, v4, s[52:55], 0 offen offset:0
  buffer_load_ushort v31, v4, s[52:55], 0 offen offset:128
  buffer_load_ushort v32, v4, s[52:55], 0 offen offset:256
  buffer_load_ushort v33, v4, s[52:55], 0 offen offset:384
  buffer_load_ushort v34, v4, s[52:55], 0 offen offset:512
  buffer_load_ushort v35, v4, s[52:55], 0 offen offset:640
  buffer_load_ushort v36, v4, s[52:55], 0 offen offset:768
  buffer_load_ushort v37, v4, s[52:55], 0 offen offset:896
  buffer_load_ushort v38, v4, s[52:55], 0 offen offset:1024
  global_load_dword v3, v2, s[24:25] sc1
  s_add_u32 s56, s10, s40
  s_addc_u32 s57, s11, 0
  s_barrier
  s_mov_b32 s36, s56
  s_mov_b32 s37, s57
  s_mov_b32 m0, 131072
  s_nop 0
  global_load_lds_dwordx4 v22, s[36:37] nt
  s_add_u32 s36, s36, 65536
  s_addc_u32 s37, s37, 0
  s_mov_b32 m0, 132096
  s_nop 0
  global_load_lds_dwordx4 v22, s[36:37] nt
  s_add_u32 s36, s36, 65536
  s_addc_u32 s37, s37, 0
  s_mov_b32 m0, 133120
  s_nop 0
  global_load_lds_dwordx4 v22, s[36:37] nt
  s_add_u32 s36, s36, 65536
  s_addc_u32 s37, s37, 0
  s_mov_b32 m0, 134144
  s_nop 0
  global_load_lds_dwordx4 v22, s[36:37] nt
  s_add_u32 s36, s36, 65536
  s_addc_u32 s37, s37, 0
  s_mov_b32 m0, 135168
  s_nop 0
  global_load_lds_dwordx4 v22, s[36:37] nt
  s_add_u32 s36, s36, 65536
  s_addc_u32 s37, s37, 0
  s_mov_b32 m0, 136192
  s_nop 0
  global_load_lds_dwordx4 v22, s[36:37] nt
  s_add_u32 s36, s36, 65536
  s_addc_u32 s37, s37, 0
  s_mov_b32 m0, 137216
  s_nop 0
  global_load_lds_dwordx4 v22, s[36:37] nt
  s_add_u32 s36, s36, 65536
  s_addc_u32 s37, s37, 0
  s_mov_b32 m0, 138240
  s_nop 0
  global_load_lds_dwordx4 v22, s[36:37] nt
  s_add_u32 s36, s36, 65536
  s_addc_u32 s37, s37, 0
  s_mov_b32 m0, 139264
  s_nop 0
  global_load_lds_dwordx4 v22, s[36:37] nt
  s_add_u32 s36, s36, 65536
  s_addc_u32 s37, s37, 0
  s_mov_b32 m0, 140288
  s_nop 0
  global_load_lds_dwordx4 v22, s[36:37] nt
  s_add_u32 s36, s36, 65536
  s_addc_u32 s37, s37, 0
  s_mov_b32 m0, 141312
  s_nop 0
  global_load_lds_dwordx4 v22, s[36:37] nt
  s_add_u32 s36, s36, 65536
  s_addc_u32 s37, s37, 0
  s_mov_b32 m0, 142336
  s_nop 0
  global_load_lds_dwordx4 v22, s[36:37] nt
  s_add_u32 s36, s36, 65536
  s_addc_u32 s37, s37, 0
  s_mov_b32 m0, 143360
  s_nop 0
  global_load_lds_dwordx4 v22, s[36:37] nt
  s_add_u32 s36, s36, 65536
  s_addc_u32 s37, s37, 0
  s_mov_b32 m0, 144384
  s_nop 0
  global_load_lds_dwordx4 v22, s[36:37] nt
  s_add_u32 s36, s36, 65536
  s_addc_u32 s37, s37, 0
  s_mov_b32 m0, 145408
  s_nop 0
  global_load_lds_dwordx4 v22, s[36:37] nt
  s_add_u32 s36, s36, 65536
  s_addc_u32 s37, s37, 0
  s_mov_b32 m0, 146432
  s_nop 0
  global_load_lds_dwordx4 v22, s[36:37] nt
  s_add_u32 s36, s36, 65536
  s_addc_u32 s37, s37, 0
  s_mov_b32 m0, 147456
  s_nop 0
  global_load_lds_dwordx4 v22, s[36:37] nt
  s_add_u32 s36, s36, 65536
  s_addc_u32 s37, s37, 0
  s_mov_b32 m0, 148480
  s_nop 0
  global_load_lds_dwordx4 v22, s[36:37] nt
  s_and_b32 s40, s27, 1
  s_lshl_b32 s96, s27, 2
  s_and_b32 s41, s28, 3
  s_add_u32 s96, s96, s41
  s_xor_b32 s41, s40, 1
  s_lshl_b32 s41, s41, 2
  s_bfe_u32 s42, s27, 0x20001
  s_add_u32 s41, s41, s42
  s_add_u32 s97, s27, 64
  s_cmp_lt_u32 s27, 8
  s_cselect_b32 s97, s97, 255
  s_cmp_eq_u32 s28, s41
  s_cselect_b32 s97, s97, 255
  s_lshr_b32 s41, s28, 2
  s_cmp_eq_u32 s41, s40
  s_cselect_b32 s96, s96, s97
  s_mul_i32 s97, s27, 3
  s_sub_u32 s40, s28, s97
  s_and_b32 s40, s40, 7
  s_add_u32 s97, s97, s40
  s_cmp_lt_u32 s40, 3
  s_cselect_b32 s97, s97, 255
  s_cmp_ge_u32 s28, 8
  s_cselect_b32 s97, s97, 255
  s_lshl_b32 s40, s27, 13
  s_add_u32 s40, s40, 65536
  s_add_u32 s62, s24, s40
  s_addc_u32 s63, s25, 0
  v_lshrrev_b32 v14, 5, v1
  v_lshlrev_b32 v14, 11, v14
  v_and_b32 v15, 31, v1
  v_lshl_add_u32 v14, v15, 4, v14
  v_add_u32 v15, 4096, v14
  v_lshrrev_b32 v26, 4, v1
  v_and_b32 v27, 15, v1
  v_lshlrev_b32 v20, 3, v26
  v_add_u32 v20, 149504, v20
  v_lshrrev_b32 v28, 2, v27
  v_lshl_add_u32 v28, v26, 2, v28
  v_and_b32 v29, 3, v27
  v_lshlrev_b32 v8, 7, v28
  v_lshl_add_u32 v8, v29, 3, v8
  v_add_u32 v8, 131072, v8
  v_lshrrev_b32 v9, 1, v28
  v_and_b32 v9, 3, v9
  v_xor_b32 v10, 0, v9
  v_lshl_add_u32 v16, v10, 5, v8
  v_xor_b32 v10, 1, v9
  v_lshl_add_u32 v17, v10, 5, v8
  v_xor_b32 v10, 2, v9
  v_lshl_add_u32 v18, v10, 5, v8
  v_xor_b32 v10, 3, v9
  v_lshl_add_u32 v19, v10, 5, v8
  v_mul_u32_u24 v24, 1152, v28
  v_lshl_add_u32 v24, v29, 3, v24
  v_add_u32 v24, 131072, v24
  s_waitcnt vmcnt(18)
  v_readfirstlane_b32 s29, v3
  v_lshlrev_b32 v30, 16, v30
  v_lshlrev_b32 v31, 16, v31
  v_lshlrev_b32 v32, 16, v32
  v_lshlrev_b32 v33, 16, v33
  v_lshlrev_b32 v34, 16, v34
  v_lshlrev_b32 v35, 16, v35
  v_lshlrev_b32 v36, 16, v36
  v_lshlrev_b32 v37, 16, v37
  v_lshlrev_b32 v38, 16, v38
  s_add_u32 s29, s29, 1
  s_bitset1_b32 s29, 31
  v_add_f32 v10, v30, v31
  v_add_f32 v10, v10, v32
  v_add_f32 v10, v10, v33
  v_add_f32 v10, v10, v34
  v_add_f32 v10, v10, v35
  v_add_f32 v10, v10, v36
  v_add_f32 v10, v10, v37
  v_add_f32 v10, v10, v38
  s_nop 1
  v_add_f32_dpp v10, v10, v10 row_ror:8 row_mask:0xf bank_mask:0xf
  s_nop 1
  v_add_f32_dpp v10, v10, v10 row_ror:4 row_mask:0xf bank_mask:0xf
  s_nop 1
  v_add_f32_dpp v10, v10, v10 row_ror:2 row_mask:0xf bank_mask:0xf
  s_nop 1
  v_add_f32_dpp v10, v10, v10 row_ror:1 row_mask:0xf bank_mask:0xf
  v_mov_b32 v11, v10
  s_nop 1
  v_permlane16_swap_b32 v10, v11
  s_nop 1
  v_add_f32 v10, v10, v11
  v_mov_b32 v11, v10
  s_nop 1
  v_permlane32_swap_b32 v10, v11
  s_nop 1
  v_add_f32 v10, v10, v11
  v_mul_f32 v10, 0x3ae38e39, v10
  v_sub_f32 v40, v30, v10
  v_sub_f32 v41, v31, v10
  v_sub_f32 v42, v32, v10
  s_branch L_pad_2_skip
L_pad_2:
  s_branch L_pad_9
L_pad_2_skip:
  v_sub_f32 v43, v33, v10
  v_sub_f32 v44, v34, v10
  v_sub_f32 v45, v35, v10
  v_sub_f32 v46, v36, v10
  v_sub_f32 v47, v37, v10
  v_sub_f32 v48, v38, v10
  v_mul_f32 v12, v40, v40
  v_fmac_f32 v12, v41, v41
  v_fmac_f32 v12, v42, v42
  v_fmac_f32 v12, v43, v43
  v_fmac_f32 v12, v44, v44
  v_fmac_f32 v12, v45, v45
  v_fmac_f32 v12, v46, v46
  v_fmac_f32 v12, v47, v47
  v_fmac_f32 v12, v48, v48
  s_nop 1
  v_add_f32_dpp v12, v12, v12 row_ror:8 row_mask:0xf bank_mask:0xf
  s_nop 1
  v_add_f32_dpp v12, v12, v12 row_ror:4 row_mask:0xf bank_mask:0xf
  s_nop 1
  v_add_f32_dpp v12, v12, v12 row_ror:2 row_mask:0xf bank_mask:0xf
  s_nop 1
  v_add_f32_dpp v12, v12, v12 row_ror:1 row_mask:0xf bank_mask:0xf
  v_mov_b32 v11, v12
  s_nop 1
  v_permlane16_swap_b32 v12, v11
  s_nop 1
  v_add_f32 v12, v12, v11
  v_mov_b32 v11, v12
  s_nop 1
  v_permlane32_swap_b32 v12, v11
  s_nop 1
  v_add_f32 v12, v12, v11
  v_mul_f32 v12, 0x3ae38e39, v12
  v_cvt_pk_bf16_f32 v11, v10, v10
  v_lshlrev_b32 v10, 16, v11
  v_cvt_pk_bf16_f32 v11, v12, v12
  v_lshlrev_b32 v12, 16, v11
  v_add_f32 v12, 0x3727c5ac, v12
  v_cvt_pk_bf16_f32 v11, v12, v12
  v_lshlrev_b32 v12, 16, v11
  v_sqrt_f32 v12, v12
  s_nop 0
  v_cvt_pk_bf16_f32 v11, v12, v12
  v_lshlrev_b32 v12, 16, v11
  v_rcp_f32 v13, v12
  v_sub_f32 v40, v30, v10
  v_sub_f32 v41, v31, v10
  v_sub_f32 v42, v32, v10
  v_sub_f32 v43, v33, v10
  v_sub_f32 v44, v34, v10
  v_sub_f32 v45, v35, v10
  v_sub_f32 v46, v36, v10
  v_sub_f32 v47, v37, v10
  v_sub_f32 v48, v38, v10
  v_cvt_pk_bf16_f32 v50, v40, v41
  v_cvt_pk_bf16_f32 v51, v42, v43
  v_cvt_pk_bf16_f32 v52, v44, v45
  v_cvt_pk_bf16_f32 v53, v46, v47
  v_cvt_pk_bf16_f32 v54, v48, v48
  v_lshlrev_b32 v40, 16, v50
  v_and_b32 v41, 0xffff0000, v50
  v_lshlrev_b32 v42, 16, v51
  v_and_b32 v43, 0xffff0000, v51
  v_lshlrev_b32 v44, 16, v52
  v_and_b32 v45, 0xffff0000, v52
  v_lshlrev_b32 v46, 16, v53
  v_and_b32 v47, 0xffff0000, v53
  v_lshlrev_b32 v48, 16, v54
  v_mul_f32 v60, v40, v13
  v_fma_f32 v70, -v60, v12, v40
  v_fma_f32 v60, v70, v13, v60
  v_mul_f32 v61, v41, v13
  v_fma_f32 v71, -v61, v12, v41
  v_fma_f32 v61, v71, v13, v61
  v_mul_f32 v62, v42, v13
  v_fma_f32 v72, -v62, v12, v42
  v_fma_f32 v62, v72, v13, v62
  v_mul_f32 v63, v43, v13
  v_fma_f32 v73, -v63, v12, v43
  v_fma_f32 v63, v73, v13, v63
  v_mul_f32 v64, v44, v13
  v_fma_f32 v74, -v64, v12, v44
  v_fma_f32 v64, v74, v13, v64
  v_mul_f32 v65, v45, v13
  v_fma_f32 v75, -v65, v12, v45
  v_fma_f32 v65, v75, v13, v65
  v_mul_f32 v66, v46, v13
  v_fma_f32 v76, -v66, v12, v46
  v_fma_f32 v66, v76, v13, v66
  v_mul_f32 v67, v47, v13
  v_fma_f32 v77, -v67, v12, v47
  v_fma_f32 v67, v77, v13, v67
  v_mul_f32 v68, v48, v13
  v_fma_f32 v78, -v68, v12, v48
  v_fma_f32 v68, v78, v13, v68
  v_cvt_pk_bf16_f32 v50, v60, v61
  v_cvt_pk_bf16_f32 v51, v62, v63
  v_cvt_pk_bf16_f32 v52, v64, v65
  v_cvt_pk_bf16_f32 v53, v66, v67
  v_cvt_pk_bf16_f32 v54, v68, v68
  v_add_u32 v11, 149504, v4
  ds_write_b16 v11, v50 offset:0
  ds_write_b16_d16_hi v11, v50 offset:128
  ds_write_b16 v11, v51 offset:256
  ds_write_b16_d16_hi v11, v51 offset:384
  ds_write_b16 v11, v52 offset:512
  ds_write_b16_d16_hi v11, v52 offset:640
  ds_write_b16 v11, v53 offset:768
  ds_write_b16_d16_hi v11, v53 offset:896
  ds_write_b16 v11, v54 offset:1024
  s_mul_i32 s58, s51, 288
  s_waitcnt vmcnt(0) lgkmcnt(0)
  v_add_u32 v21, s58, v20
  ds_read_b64 v[40:41], v21 offset:0
  ds_read_b64_tr_b16 v[42:43], v16 offset:0
  ds_read_b64_tr_b16 v[44:45], v17 offset:0
  ds_read_b64_tr_b16 v[46:47], v18 offset:0
  ds_read_b64_tr_b16 v[48:49], v19 offset:0
  ds_read_b64 v[50:51], v21 offset:32
  ds_read_b64_tr_b16 v[52:53], v16 offset:2048
  ds_read_b64_tr_b16 v[54:55], v17 offset:2048
  ds_read_b64_tr_b16 v[56:57], v18 offset:2048
  ds_read_b64_tr_b16 v[58:59], v19 offset:2048
  ds_read_b64 v[60:61], v21 offset:64
  ds_read_b64_tr_b16 v[62:63], v16 offset:4096
  ds_read_b64_tr_b16 v[64:65], v17 offset:4096
  ds_read_b64_tr_b16 v[66:67], v18 offset:4096
  ds_read_b64_tr_b16 v[68:69], v19 offset:4096
  s_waitcnt lgkmcnt(10)
  v_mfma_f32_16x16x16_bf16 v[96:99], v[40:41], v[42:43], 0
  v_mfma_f32_16x16x16_bf16 v[100:103], v[40:41], v[44:45], 0
  v_mfma_f32_16x16x16_bf16 v[104:107], v[40:41], v[46:47], 0
  v_mfma_f32_16x16x16_bf16 v[108:111], v[40:41], v[48:49], 0
  ds_read_b64 v[70:71], v21 offset:96
  ds_read_b64_tr_b16 v[72:73], v16 offset:6144
  ds_read_b64_tr_b16 v[74:75], v17 offset:6144
  ds_read_b64_tr_b16 v[76:77], v18 offset:6144
  ds_read_b64_tr_b16 v[78:79], v19 offset:6144
  s_waitcnt lgkmcnt(10)
  v_mfma_f32_16x16x16_bf16 v[96:99], v[50:51], v[52:53], v[96:99]
  v_mfma_f32_16x16x16_bf16 v[100:103], v[50:51], v[54:55], v[100:103]
  v_mfma_f32_16x16x16_bf16 v[104:107], v[50:51], v[56:57], v[104:107]
  v_mfma_f32_16x16x16_bf16 v[108:111], v[50:51], v[58:59], v[108:111]
  ds_read_b64 v[80:81], v21 offset:128
  ds_read_b64_tr_b16 v[82:83], v16 offset:8192
  ds_read_b64_tr_b16 v[84:85], v17 offset:8192
  ds_read_b64_tr_b16 v[86:87], v18 offset:8192
  ds_read_b64_tr_b16 v[88:89], v19 offset:8192
  s_waitcnt lgkmcnt(10)
  v_mfma_f32_16x16x16_bf16 v[96:99], v[60:61], v[62:63], v[96:99]
  v_mfma_f32_16x16x16_bf16 v[100:103], v[60:61], v[64:65], v[100:103]
  v_mfma_f32_16x16x16_bf16 v[104:107], v[60:61], v[66:67], v[104:107]
  v_mfma_f32_16x16x16_bf16 v[108:111], v[60:61], v[68:69], v[108:111]
  ds_read_b64 v[40:41], v21 offset:160
  ds_read_b64_tr_b16 v[42:43], v16 offset:10240
  ds_read_b64_tr_b16 v[44:45], v17 offset:10240
  ds_read_b64_tr_b16 v[46:47], v18 offset:10240
  ds_read_b64_tr_b16 v[48:49], v19 offset:10240
  s_waitcnt lgkmcnt(10)
  v_mfma_f32_16x16x16_bf16 v[96:99], v[70:71], v[72:73], v[96:99]
  v_mfma_f32_16x16x16_bf16 v[100:103], v[70:71], v[74:75], v[100:103]
  v_mfma_f32_16x16x16_bf16 v[104:107], v[70:71], v[76:77], v[104:107]
  v_mfma_f32_16x16x16_bf16 v[108:111], v[70:71], v[78:79], v[108:111]
  ds_read_b64 v[50:51], v21 offset:192
  ds_read_b64_tr_b16 v[52:53], v16 offset:12288
  ds_read_b64_tr_b16 v[54:55], v17 offset:12288
  ds_read_b64_tr_b16 v[56:57], v18 offset:12288
  ds_read_b64_tr_b16 v[58:59], v19 offset:12288
  s_waitcnt lgkmcnt(10)
  v_mfma_f32_16x16x16_bf16 v[96:99], v[80:81], v[82:83], v[96:99]
  v_mfma_f32_16x16x16_bf16 v[100:103], v[80:81], v[84:85], v[100:103]
  v_mfma_f32_16x16x16_bf16 v[104:107], v[80:81], v[86:87], v[104:107]
  v_mfma_f32_16x16x16_bf16 v[108:111], v[80:81], v[88:89], v[108:111]
  ds_read_b64 v[60:61], v21 offset:224
  ds_read_b64_tr_b16 v[62:63], v16 offset:14336
  ds_read_b64_tr_b16 v[64:65], v17 offset:14336
  ds_read_b64_tr_b16 v[66:67], v18 offset:14336
  ds_read_b64_tr_b16 v[68:69], v19 offset:14336
  s_waitcnt lgkmcnt(10)
  v_mfma_f32_16x16x16_bf16 v[96:99], v[40:41], v[42:43], v[96:99]
  v_mfma_f32_16x16x16_bf16 v[100:103], v[40:41], v[44:45], v[100:103]
  v_mfma_f32_16x16x16_bf16 v[104:107], v[40:41], v[46:47], v[104:107]
  v_mfma_f32_16x16x16_bf16 v[108:111], v[40:41], v[48:49], v[108:111]
  ds_read_b64 v[70:71], v21 offset:256
  ds_read_b64_tr_b16 v[72:73], v16 offset:16384
  ds_read_b64_tr_b16 v[74:75], v17 offset:16384
  ds_read_b64_tr_b16 v[76:77], v18 offset:16384
  ds_read_b64_tr_b16 v[78:79], v19 offset:16384
  s_waitcnt lgkmcnt(10)
  v_mfma_f32_16x16x16_bf16 v[96:99], v[50:51], v[52:53], v[96:99]
  v_mfma_f32_16x16x16_bf16 v[100:103], v[50:51], v[54:55], v[100:103]
  v_mfma_f32_16x16x16_bf16 v[104:107], v[50:51], v[56:57], v[104:107]
  s_branch L_pad_3_skip
L_pad_3:
  s_branch L_chain_done
L_pad_3_skip:
  v_mfma_f32_16x16x16_bf16 v[108:111], v[50:51], v[58:59], v[108:111]
  s_waitcnt lgkmcnt(5)
  v_mfma_f32_16x16x16_bf16 v[96:99], v[60:61], v[62:63], v[96:99]
  v_mfma_f32_16x16x16_bf16 v[100:103], v[60:61], v[64:65], v[100:103]
  v_mfma_f32_16x16x16_bf16 v[104:107], v[60:61], v[66:67], v[104:107]
  v_mfma_f32_16x16x16_bf16 v[108:111], v[60:61], v[68:69], v[108:111]
  s_waitcnt lgkmcnt(0)
  v_mfma_f32_16x16x16_bf16 v[96:99], v[70:71], v[72:73], v[96:99]
  v_mfma_f32_16x16x16_bf16 v[100:103], v[70:71], v[74:75], v[100:103]
  v_mfma_f32_16x16x16_bf16 v[104:107], v[70:71], v[76:77], v[104:107]
  v_mfma_f32_16x16x16_bf16 v[108:111], v[70:71], v[78:79], v[108:111]
  s_nop 7
  s_mov_b32 s46, 0xffff0000
  s_mov_b32 s47, 0
  v_cndmask_b32 v32, v96, v104, s[46:47]
  v_cndmask_b32 v34, v100, v108, s[46:47]
  v_mov_b32 v33, s29
  v_mov_b32 v35, s29
  s_lshl_b32 s40, s2, 9
  s_add_u32 s40, s40, 65536
  s_add_u32 s48, s24, s40
  s_addc_u32 s49, s25, 0
  s_mov_b32 s46, -1
  s_mov_b64 exec, s[46:47]
  global_store_dwordx4 v23, v[32:35], s[48:49] sc1
  s_mov_b64 exec, -1
  s_mov_b32 s48, s62
  s_mov_b32 s49, s63
  v_mov_b32 v30, v14
  v_mov_b32 v31, v15
  s_mov_b64 s[60:61], -1
  s_mov_b32 s63, 1
  s_mov_b32 s64, 262144
L_h_q_loop:
  s_bcnt1_i32_b64 s62, s[60:61]
  s_cmp_le_u32 s62, 8
  s_cselect_b32 s63, 1, s63
  s_mov_b64 exec, s[60:61]
  s_cmp_lg_u32 s63, 0
  s_cbranch_scc1 L_h_q_go
  s_ff1_i32_b64 s62, s[60:61]
  s_lshl_b64 exec, 1, s62
L_h_q_go:
  global_load_dwordx4 v[40:43], v30, s[48:49] offset:0 sc1
  global_load_dwordx4 v[44:47], v30, s[48:49] offset:512 sc1
  global_load_dwordx4 v[48:51], v30, s[48:49] offset:1024 sc1
  global_load_dwordx4 v[52:55], v30, s[48:49] offset:1536 sc1
  global_load_dwordx4 v[56:59], v31, s[48:49] offset:0 sc1
  global_load_dwordx4 v[60:63], v31, s[48:49] offset:512 sc1
  global_load_dwordx4 v[64:67], v31, s[48:49] offset:1024 sc1
  global_load_dwordx4 v[68:71], v31, s[48:49] offset:1536 sc1
  s_waitcnt vmcnt(0)
  v_xor_b32 v72, s29, v41
  v_xor_b32 v73, s29, v43
  v_or_b32 v72, v72, v73
  v_xor_b32 v73, s29, v45
  v_or_b32 v72, v72, v73
  v_xor_b32 v73, s29, v47
  v_or_b32 v72, v72, v73
  v_xor_b32 v73, s29, v49
  v_or_b32 v72, v72, v73
  v_xor_b32 v73, s29, v51
  v_or_b32 v72, v72, v73
  v_xor_b32 v73, s29, v53
  v_or_b32 v72, v72, v73
  v_xor_b32 v73, s29, v55
  v_or_b32 v72, v72, v73
  v_xor_b32 v73, s29, v57
  v_or_b32 v72, v72, v73
  v_xor_b32 v73, s29, v59
  v_or_b32 v72, v72, v73
  v_xor_b32 v73, s29, v61
  v_or_b32 v72, v72, v73
  v_xor_b32 v73, s29, v63
  v_or_b32 v72, v72, v73
  v_xor_b32 v73, s29, v65
  v_or_b32 v72, v72, v73
  v_xor_b32 v73, s29, v67
  v_or_b32 v72, v72, v73
  v_xor_b32 v73, s29, v69
  v_or_b32 v72, v72, v73
  v_xor_b32 v73, s29, v71
  v_or_b32 v72, v72, v73
  v_cmp_eq_u32 vcc, 0, v72
  s_andn2_b64 s[60:61], s[60:61], vcc
  s_cmp_lg_u64 vcc, 0
  s_cselect_b32 s62, 1, 0
  s_xor_b32 s63, s63, 1
  s_and_b32 s63, s63, s62
  s_mov_b64 exec, -1
  s_cmp_eq_u64 s[60:61], 0
  s_cbranch_scc1 L_h_q_done
  s_bcnt1_i32_b64 s62, s[60:61]
  s_cmp_le_u32 s62, 8
  s_cbranch_scc1 L_h_q_ns
  s_sleep 1
L_h_q_ns:
  s_sub_u32 s64, s64, 1
  s_cmp_lg_u32 s64, 0
  s_cbranch_scc1 L_h_q_loop
L_h_q_done:
  v_add_f32 v40, v40, v44
  v_add_f32 v48, v48, v52
  v_add_f32 v40, v40, v48
  v_add_f32 v42, v42, v46
  v_add_f32 v50, v50, v54
  v_add_f32 v42, v42, v50
  v_cvt_pk_bf16_f32 v74, v40, v42
  v_add_f32 v56, v56, v60
  v_add_f32 v64, v64, v68
  v_add_f32 v56, v56, v64
  v_add_f32 v58, v58, v62
  v_add_f32 v66, v66, v70
  v_add_f32 v58, v58, v66
  v_cvt_pk_bf16_f32 v75, v56, v58
  v_lshrrev_b32 v32, 4, v1
  v_lshlrev_b32 v32, 6, v32
  v_lshl_add_u32 v32, v27, 1, v32
  v_add_u32 v32, 150784, v32
  ds_write_b16 v32, v74 offset:0
  ds_write_b16_d16_hi v32, v74 offset:32
  ds_write_b16 v32, v75 offset:256
  ds_write_b16_d16_hi v32, v75 offset:288
  v_mov_b32 v42, 1
  v_mov_b32 v43, s29
  v_mov_b32 v41, 151552
  s_waitcnt lgkmcnt(0)
  s_mov_b64 exec, 1
  ds_write_b64 v41, v[42:43] offset:32
  s_mov_b64 exec, -1
  s_setprio 0
  s_cmp_ge_u32 s96, 72
  s_cbranch_scc1 L_h_ffn_done
  s_mov_b32 s59, 0
L_h_f1:
  s_lshl_b32 s40, s96, 7
  s_mul_i32 s58, s59, 1327104
  s_add_u32 s40, s40, s58
  s_add_u32 s56, s16, s40
  s_addc_u32 s57, s17, 0
  s_mov_b32 s36, s56
  s_mov_b32 s37, s57
  s_mov_b32 m0, 131072
  s_waitcnt vmcnt(5)
  global_load_lds_dwordx4 v25, s[36:37] nt
  s_add_u32 s36, s36, 73728
  s_addc_u32 s37, s37, 0
  s_mov_b32 m0, 132096
  s_waitcnt vmcnt(5)
  global_load_lds_dwordx4 v25, s[36:37] nt
  s_add_u32 s36, s36, 73728
  s_addc_u32 s37, s37, 0
  s_mov_b32 m0, 133120
  s_waitcnt vmcnt(5)
  global_load_lds_dwordx4 v25, s[36:37] nt
  s_add_u32 s36, s36, 73728
  s_addc_u32 s37, s37, 0
  s_mov_b32 m0, 134144
  s_waitcnt vmcnt(5)
  global_load_lds_dwordx4 v25, s[36:37] nt
  s_add_u32 s36, s36, 73728
  s_addc_u32 s37, s37, 0
  s_mov_b32 m0, 135168
  s_waitcnt vmcnt(5)
  global_load_lds_dwordx4 v25, s[36:37] nt
  s_add_u32 s36, s36, 73728
  s_addc_u32 s37, s37, 0
  s_mov_b32 m0, 136192
  s_waitcnt vmcnt(5)
  global_load_lds_dwordx4 v25, s[36:37] nt
  s_add_u32 s36, s36, 73728
  s_addc_u32 s37, s37, 0
  s_mov_b32 m0, 137216
  s_waitcnt vmcnt(5)
  global_load_lds_dwordx4 v25, s[36:37] nt
  s_add_u32 s36, s36, 73728
  s_addc_u32 s37, s37, 0
  s_mov_b32 m0, 138240
  s_waitcnt vmcnt(5)
  global_load_lds_dwordx4 v25, s[36:37] nt
  s_add_u32 s36, s36, 73728
  s_addc_u32 s37, s37, 0
  s_mov_b32 m0, 139264
  s_waitcnt vmcnt(5)
  global_load_lds_dwordx4 v25, s[36:37] nt
  s_add_u32 s36, s36, 73728
  s_addc_u32 s37, s37, 0
  s_mov_b32 m0, 140288
  s_waitcnt vmcnt(5)
  global_load_lds_dwordx4 v25, s[36:37] nt
  s_add_u32 s36, s36, 73728
  s_addc_u32 s37, s37, 0
  s_mov_b32 m0, 141312
  s_waitcnt vmcnt(5)
  global_load_lds_dwordx4 v25, s[36:37] nt
  s_add_u32 s36, s36, 73728
  s_addc_u32 s37, s37, 0
  s_mov_b32 m0, 142336
  s_waitcnt vmcnt(5)
  global_load_lds_dwordx4 v25, s[36:37] nt
  s_add_u32 s36, s36, 73728
  s_addc_u32 s37, s37, 0
  s_mov_b32 m0, 143360
  s_waitcnt vmcnt(5)
  global_load_lds_dwordx4 v25, s[36:37] nt
  s_add_u32 s36, s36, 73728
  s_addc_u32 s37, s37, 0
  s_mov_b32 m0, 144384
  s_waitcnt vmcnt(5)
  global_load_lds_dwordx4 v25, s[36:37] nt
  s_add_u32 s36, s36, 73728
  s_addc_u32 s37, s37, 0
  s_mov_b32 m0, 145408
  s_waitcnt vmcnt(5)
  global_load_lds_dwordx4 v25, s[36:37] nt
  s_add_u32 s36, s36, 73728
  s_addc_u32 s37, s37, 0
  s_mov_b32 m0, 146432
  s_waitcnt vmcnt(5)
  global_load_lds_dwordx4 v25, s[36:37] nt
  s_add_u32 s36, s36, 73728
  s_addc_u32 s37, s37, 0
  s_mov_b32 m0, 147456
  s_waitcnt vmcnt(5)
  global_load_lds_dwordx4 v25, s[36:37] nt
  s_add_u32 s36, s36, 73728
  s_addc_u32 s37, s37, 0
  s_mov_b32 m0, 148480
  s_waitcnt vmcnt(5)
  global_load_lds_dwordx4 v25, s[36:37] nt
  s_mul_i32 s58, s59, 288
  s_waitcnt vmcnt(0)
  s_cmp_lg_u32 s59, 0
  s_cbranch_scc1 L_h_f1b
  v_mov_b32 v96, 0
  v_mov_b32 v97, 0
  v_mov_b32 v98, 0
  v_mov_b32 v99, 0
  v_mov_b32 v100, 0
  v_mov_b32 v101, 0
  v_mov_b32 v102, 0
  v_mov_b32 v103, 0
  v_mov_b32 v104, 0
  v_mov_b32 v105, 0
  v_mov_b32 v106, 0
  v_mov_b32 v107, 0
  v_mov_b32 v108, 0
  v_mov_b32 v109, 0
  v_mov_b32 v110, 0
  v_mov_b32 v111, 0
L_h_f1b:
  s_nop 1
  v_add_u32 v21, s58, v20
  ds_read_b64 v[40:41], v21 offset:0
  ds_read_b64_tr_b16 v[42:43], v16 offset:0
  ds_read_b64_tr_b16 v[44:45], v17 offset:0
  ds_read_b64_tr_b16 v[46:47], v18 offset:0
  ds_read_b64_tr_b16 v[48:49], v19 offset:0
  ds_read_b64 v[50:51], v21 offset:32
  ds_read_b64_tr_b16 v[52:53], v16 offset:2048
  ds_read_b64_tr_b16 v[54:55], v17 offset:2048
  ds_read_b64_tr_b16 v[56:57], v18 offset:2048
  ds_read_b64_tr_b16 v[58:59], v19 offset:2048
  ds_read_b64 v[60:61], v21 offset:64
  ds_read_b64_tr_b16 v[62:63], v16 offset:4096
  ds_read_b64_tr_b16 v[64:65], v17 offset:4096
  ds_read_b64_tr_b16 v[66:67], v18 offset:4096
  ds_read_b64_tr_b16 v[68:69], v19 offset:4096
  s_waitcnt lgkmcnt(10)
  v_mfma_f32_16x16x16_bf16 v[96:99], v[40:41], v[42:43], v[96:99]
  v_mfma_f32_16x16x16_bf16 v[100:103], v[40:41], v[44:45], v[100:103]
  v_mfma_f32_16x16x16_bf16 v[104:107], v[40:41], v[46:47], v[104:107]
  v_mfma_f32_16x16x16_bf16 v[108:111], v[40:41], v[48:49], v[108:111]
  ds_read_b64 v[70:71], v21 offset:96
  ds_read_b64_tr_b16 v[72:73], v16 offset:6144
  ds_read_b64_tr_b16 v[74:75], v17 offset:6144
  ds_read_b64_tr_b16 v[76:77], v18 offset:6144
  ds_read_b64_tr_b16 v[78:79], v19 offset:6144
  s_waitcnt lgkmcnt(10)
  v_mfma_f32_16x16x16_bf16 v[96:99], v[50:51], v[52:53], v[96:99]
  v_mfma_f32_16x16x16_bf16 v[100:103], v[50:51], v[54:55], v[100:103]
  v_mfma_f32_16x16x16_bf16 v[104:107], v[50:51], v[56:57], v[104:107]
  v_mfma_f32_16x16x16_bf16 v[108:111], v[50:51], v[58:59], v[108:111]
  ds_read_b64 v[80:81], v21 offset:128
  ds_read_b64_tr_b16 v[82:83], v16 offset:8192
  ds_read_b64_tr_b16 v[84:85], v17 offset:8192
  ds_read_b64_tr_b16 v[86:87], v18 offset:8192
  ds_read_b64_tr_b16 v[88:89], v19 offset:8192
  s_waitcnt lgkmcnt(10)
  v_mfma_f32_16x16x16_bf16 v[96:99], v[60:61], v[62:63], v[96:99]
  v_mfma_f32_16x16x16_bf16 v[100:103], v[60:61], v[64:65], v[100:103]
  v_mfma_f32_16x16x16_bf16 v[104:107], v[60:61], v[66:67], v[104:107]
  v_mfma_f32_16x16x16_bf16 v[108:111], v[60:61], v[68:69], v[108:111]
  ds_read_b64 v[40:41], v21 offset:160
  ds_read_b64_tr_b16 v[42:43], v16 offset:10240
  ds_read_b64_tr_b16 v[44:45], v17 offset:10240
  ds_read_b64_tr_b16 v[46:47], v18 offset:10240
  ds_read_b64_tr_b16 v[48:49], v19 offset:10240
  s_waitcnt lgkmcnt(10)
  v_mfma_f32_16x16x16_bf16 v[96:99], v[70:71], v[72:73], v[96:99]
  v_mfma_f32_16x16x16_bf16 v[100:103], v[70:71], v[74:75], v[100:103]
  v_mfma_f32_16x16x16_bf16 v[104:107], v[70:71], v[76:77], v[104:107]
  v_mfma_f32_16x16x16_bf16 v[108:111], v[70:71], v[78:79], v[108:111]
  ds_read_b64 v[50:51], v21 offset:192
  ds_read_b64_tr_b16 v[52:53], v16 offset:12288
  ds_read_b64_tr_b16 v[54:55], v17 offset:12288
  ds_read_b64_tr_b16 v[56:57], v18 offset:12288
  ds_read_b64_tr_b16 v[58:59], v19 offset:12288
  s_waitcnt lgkmcnt(10)
  v_mfma_f32_16x16x16_bf16 v[96:99], v[80:81], v[82:83], v[96:99]
  v_mfma_f32_16x16x16_bf16 v[100:103], v[80:81], v[84:85], v[100:103]
  v_mfma_f32_16x16x16_bf16 v[104:107], v[80:81], v[86:87], v[104:107]
  v_mfma_f32_16x16x16_bf16 v[108:111], v[80:81], v[88:89], v[108:111]
  ds_read_b64 v[60:61], v21 offset:224
  ds_read_b64_tr_b16 v[62:63], v16 offset:14336
  ds_read_b64_tr_b16 v[64:65], v17 offset:14336
  ds_read_b64_tr_b16 v[66:67], v18 offset:14336
  ds_read_b64_tr_b16 v[68:69], v19 offset:14336
  s_waitcnt lgkmcnt(10)
  v_mfma_f32_16x16x16_bf16 v[96:99], v[40:41], v[42:43], v[96:99]
  v_mfma_f32_16x16x16_bf16 v[100:103], v[40:41], v[44:45], v[100:103]
  v_mfma_f32_16x16x16_bf16 v[104:107], v[40:41], v[46:47], v[104:107]
  v_mfma_f32_16x16x16_bf16 v[108:111], v[40:41], v[48:49], v[108:111]
  ds_read_b64 v[70:71], v21 offset:256
  ds_read_b64_tr_b16 v[72:73], v16 offset:16384
  ds_read_b64_tr_b16 v[74:75], v17 offset:16384
  ds_read_b64_tr_b16 v[76:77], v18 offset:16384
  ds_read_b64_tr_b16 v[78:79], v19 offset:16384
  s_waitcnt lgkmcnt(10)
  v_mfma_f32_16x16x16_bf16 v[96:99], v[50:51], v[52:53], v[96:99]
  v_mfma_f32_16x16x16_bf16 v[100:103], v[50:51], v[54:55], v[100:103]
  v_mfma_f32_16x16x16_bf16 v[104:107], v[50:51], v[56:57], v[104:107]
  v_mfma_f32_16x16x16_bf16 v[108:111], v[50:51], v[58:59], v[108:111]
  s_waitcnt lgkmcnt(5)
  v_mfma_f32_16x16x16_bf16 v[96:99], v[60:61], v[62:63], v[96:99]
  v_mfma_f32_16x16x16_bf16 v[100:103], v[60:61], v[64:65], v[100:103]
  v_mfma_f32_16x16x16_bf16 v[104:107], v[60:61], v[66:67], v[104:107]
  v_mfma_f32_16x16x16_bf16 v[108:111], v[60:61], v[68:69], v[108:111]
  s_waitcnt lgkmcnt(0)
  v_mfma_f32_16x16x16_bf16 v[96:99], v[70:71], v[72:73], v[96:99]
  v_mfma_f32_16x16x16_bf16 v[100:103], v[70:71], v[74:75], v[100:103]
  v_mfma_f32_16x16x16_bf16 v[104:107], v[70:71], v[76:77], v[104:107]
  v_mfma_f32_16x16x16_bf16 v[108:111], v[70:71], v[78:79], v[108:111]
  s_add_u32 s59, s59, 1
  s_cmp_lt_u32 s59, 4
  s_cbranch_scc1 L_h_f1
  s_nop 7
  v_lshlrev_b32 v34, 1, v27
  v_add_u32 v34, 156032, v34
  v_cvt_pk_bf16_f32 v31, v96, v96
  v_lshlrev_b32 v30, 16, v31
  v_mul_f32 v31, 0xbfb8aa3b, v30
  v_exp_f32 v31, v31
  s_nop 0
  v_add_f32 v31, 1.0, v31
  v_rcp_f32 v32, v31
  s_nop 0
  v_mul_f32 v33, v30, v32
  v_cvt_pk_bf16_f32 v33, v33, v33
  s_mov_b64 exec, 0xffff
  ds_write_b16 v34, v33 offset:0
  s_mov_b64 exec, -1
  v_cvt_pk_bf16_f32 v31, v100, v100
  v_lshlrev_b32 v30, 16, v31
  v_mul_f32 v31, 0xbfb8aa3b, v30
  v_exp_f32 v31, v31
  s_nop 0
  v_add_f32 v31, 1.0, v31
  v_rcp_f32 v32, v31
  s_nop 0
  v_mul_f32 v33, v30, v32
  v_cvt_pk_bf16_f32 v33, v33, v33
  s_mov_b64 exec, 0xffff
  ds_write_b16 v34, v33 offset:32
  s_mov_b64 exec, -1
  v_cvt_pk_bf16_f32 v31, v104, v104
  v_lshlrev_b32 v30, 16, v31
  v_mul_f32 v31, 0xbfb8aa3b, v30
  v_exp_f32 v31, v31
  s_nop 0
  v_add_f32 v31, 1.0, v31
  v_rcp_f32 v32, v31
  s_nop 0
  v_mul_f32 v33, v30, v32
  v_cvt_pk_bf16_f32 v33, v33, v33
  s_mov_b64 exec, 0xffff
  ds_write_b16 v34, v33 offset:64
  s_mov_b64 exec, -1
  v_cvt_pk_bf16_f32 v31, v108, v108
  v_lshlrev_b32 v30, 16, v31
  v_mul_f32 v31, 0xbfb8aa3b, v30
  v_exp_f32 v31, v31
  s_nop 0
  v_add_f32 v31, 1.0, v31
  v_rcp_f32 v32, v31
  s_nop 0
  v_mul_f32 v33, v30, v32
  v_cvt_pk_bf16_f32 v33, v33, v33
  s_mov_b64 exec, 0xffff
  ds_write_b16 v34, v33 offset:96
  s_mov_b64 exec, -1
  v_mov_b32 v112, 0
  v_mov_b32 v113, 0
  v_mov_b32 v114, 0
  v_mov_b32 v115, 0
  v_mov_b32 v116, 0
  v_mov_b32 v117, 0
  v_mov_b32 v118, 0
  v_mov_b32 v119, 0
  v_mov_b32 v120, 0
  v_mov_b32 v121, 0
  v_mov_b32 v122, 0
  v_mov_b32 v123, 0
  v_lshlrev_b32 v35, 3, v26
  v_add_u32 v35, 156032, v35
  s_mov_b32 s59, 0
L_h_f2:
  s_lshl_b32 s40, s96, 2
  s_add_u32 s40, s40, s59
  s_mul_i32 s40, s40, 18432
  s_add_u32 s56, s18, s40
  s_addc_u32 s57, s19, 0
  s_mov_b32 s36, s56
  s_mov_b32 s37, s57
  s_mov_b32 m0, 131072
  s_nop 0
  s_waitcnt vmcnt(5)
  global_load_lds_dwordx4 v23, s[36:37] offset:0 nt
  s_waitcnt vmcnt(5)
  global_load_lds_dwordx4 v23, s[36:37] offset:1024 nt
  s_waitcnt vmcnt(5)
  global_load_lds_dwordx4 v23, s[36:37] offset:2048 nt
  s_waitcnt vmcnt(5)
  global_load_lds_dwordx4 v23, s[36:37] offset:3072 nt
  s_add_u32 s36, s36, 4096
  s_addc_u32 s37, s37, 0
  s_mov_b32 m0, 135168
  s_nop 0
  s_waitcnt vmcnt(5)
  global_load_lds_dwordx4 v23, s[36:37] offset:0 nt
  s_waitcnt vmcnt(5)
  global_load_lds_dwordx4 v23, s[36:37] offset:1024 nt
  s_waitcnt vmcnt(5)
  global_load_lds_dwordx4 v23, s[36:37] offset:2048 nt
  s_waitcnt vmcnt(5)
  global_load_lds_dwordx4 v23, s[36:37] offset:3072 nt
  s_add_u32 s36, s36, 4096
  s_addc_u32 s37, s37, 0
  s_mov_b32 m0, 139264
  s_nop 0
  s_waitcnt vmcnt(5)
  global_load_lds_dwordx4 v23, s[36:37] offset:0 nt
  s_waitcnt vmcnt(5)
  global_load_lds_dwordx4 v23, s[36:37] offset:1024 nt
  s_waitcnt vmcnt(5)
  global_load_lds_dwordx4 v23, s[36:37] offset:2048 nt
  s_waitcnt vmcnt(5)
  global_load_lds_dwordx4 v23, s[36:37] offset:3072 nt
  s_add_u32 s36, s36, 4096
  s_addc_u32 s37, s37, 0
  s_mov_b32 m0, 143360
  s_nop 0
  s_waitcnt vmcnt(5)
  global_load_lds_dwordx4 v23, s[36:37] offset:0 nt
  s_waitcnt vmcnt(5)
  global_load_lds_dwordx4 v23, s[36:37] offset:1024 nt
  s_waitcnt vmcnt(5)
  global_load_lds_dwordx4 v23, s[36:37] offset:2048 nt
  s_waitcnt vmcnt(5)
  global_load_lds_dwordx4 v23, s[36:37] offset:3072 nt
  s_add_u32 s36, s36, 4096
  s_addc_u32 s37, s37, 0
  s_mov_b32 m0, 147456
  s_nop 0
  s_waitcnt vmcnt(5)
  global_load_lds_dwordx4 v23, s[36:37] offset:0 nt
  s_waitcnt vmcnt(5)
  global_load_lds_dwordx4 v23, s[36:37] offset:1024 nt
  s_lshl_b32 s40, s59, 5
  v_add_u32 v38, s40, v35
  s_waitcnt lgkmcnt(0)
  ds_read_b64 v[36:37], v38
  s_waitcnt vmcnt(0) lgkmcnt(0)
  ds_read_b64_tr_b16 v[40:41], v24 offset:0
  ds_read_b64_tr_b16 v[42:43], v24 offset:32
  ds_read_b64_tr_b16 v[44:45], v24 offset:64
  ds_read_b64_tr_b16 v[46:47], v24 offset:96
  ds_read_b64_tr_b16 v[48:49], v24 offset:128
  ds_read_b64_tr_b16 v[50:51], v24 offset:160
  ds_read_b64_tr_b16 v[52:53], v24 offset:192
  ds_read_b64_tr_b16 v[54:55], v24 offset:224
  ds_read_b64_tr_b16 v[56:57], v24 offset:256
  ds_read_b64_tr_b16 v[58:59], v24 offset:288
  ds_read_b64_tr_b16 v[60:61], v24 offset:320
  ds_read_b64_tr_b16 v[62:63], v24 offset:352
  s_waitcnt lgkmcnt(0)
  s_mov_b32 s46, 0x10001
  s_mov_b32 s47, 0x10001
  v_cndmask_b32 v88, 0, v36, s[46:47]
  v_cndmask_b32 v89, 0, v37, s[46:47]
  s_nop 1
  v_mfma_f32_16x16x16_bf16 v[112:115], v[88:89], v[40:41], v[112:115]
  s_mov_b32 s46, 0x20002
  s_mov_b32 s47, 0x20002
  v_cndmask_b32 v90, 0, v36, s[46:47]
  v_cndmask_b32 v91, 0, v37, s[46:47]
  s_nop 1
  v_mfma_f32_16x16x16_bf16 v[112:115], v[90:91], v[42:43], v[112:115]
  s_mov_b32 s46, 0x40004
  s_mov_b32 s47, 0x40004
  v_cndmask_b32 v88, 0, v36, s[46:47]
  v_cndmask_b32 v89, 0, v37, s[46:47]
  s_nop 1
  v_mfma_f32_16x16x16_bf16 v[112:115], v[88:89], v[44:45], v[112:115]
  s_mov_b32 s46, 0x100010
  s_mov_b32 s47, 0x100010
  v_cndmask_b32 v90, 0, v36, s[46:47]
  v_cndmask_b32 v91, 0, v37, s[46:47]
  s_nop 1
  v_mfma_f32_16x16x16_bf16 v[112:115], v[90:91], v[46:47], v[112:115]
  s_mov_b32 s46, 0x200020
  s_mov_b32 s47, 0x200020
  v_cndmask_b32 v88, 0, v36, s[46:47]
  v_cndmask_b32 v89, 0, v37, s[46:47]
  s_nop 1
  v_mfma_f32_16x16x16_bf16 v[112:115], v[88:89], v[48:49], v[112:115]
  s_mov_b32 s46, 0x400040
  s_mov_b32 s47, 0x400040
  v_cndmask_b32 v90, 0, v36, s[46:47]
  v_cndmask_b32 v91, 0, v37, s[46:47]
  s_nop 1
  v_mfma_f32_16x16x16_bf16 v[112:115], v[90:91], v[50:51], v[112:115]
  s_mov_b32 s46, 0x1000100
  s_mov_b32 s47, 0x1000100
  v_cndmask_b32 v88, 0, v36, s[46:47]
  v_cndmask_b32 v89, 0, v37, s[46:47]
  s_nop 1
  v_mfma_f32_16x16x16_bf16 v[112:115], v[88:89], v[52:53], v[112:115]
  s_mov_b32 s46, 0x2000200
  s_mov_b32 s47, 0x2000200
  v_cndmask_b32 v90, 0, v36, s[46:47]
  v_cndmask_b32 v91, 0, v37, s[46:47]
  s_nop 1
  v_mfma_f32_16x16x16_bf16 v[112:115], v[90:91], v[54:55], v[112:115]
  s_mov_b32 s46, 0x4000400
  s_mov_b32 s47, 0x4000400
  v_cndmask_b32 v88, 0, v36, s[46:47]
  v_cndmask_b32 v89, 0, v37, s[46:47]
  s_nop 1
  v_mfma_f32_16x16x16_bf16 v[112:115], v[88:89], v[56:57], v[112:115]
  s_mov_b32 s46, 0x10001000
  s_mov_b32 s47, 0x10001000
  v_cndmask_b32 v90, 0, v36, s[46:47]
  v_cndmask_b32 v91, 0, v37, s[46:47]
  s_nop 1
  v_mfma_f32_16x16x16_bf16 v[112:115], v[90:91], v[58:59], v[112:115]
  s_mov_b32 s46, 0x20002000
  s_mov_b32 s47, 0x20002000
  v_cndmask_b32 v88, 0, v36, s[46:47]
  v_cndmask_b32 v89, 0, v37, s[46:47]
  s_nop 1
  v_mfma_f32_16x16x16_bf16 v[112:115], v[88:89], v[60:61], v[112:115]
  s_mov_b32 s46, 0x40004000
  s_mov_b32 s47, 0x40004000
  v_cndmask_b32 v90, 0, v36, s[46:47]
  v_cndmask_b32 v91, 0, v37, s[46:47]
  s_nop 1
  v_mfma_f32_16x16x16_bf16 v[112:115], v[90:91], v[62:63], v[112:115]
  ds_read_b64_tr_b16 v[40:41], v24 offset:384
  ds_read_b64_tr_b16 v[42:43], v24 offset:416
  ds_read_b64_tr_b16 v[44:45], v24 offset:448
  ds_read_b64_tr_b16 v[46:47], v24 offset:480
  ds_read_b64_tr_b16 v[48:49], v24 offset:512
  ds_read_b64_tr_b16 v[50:51], v24 offset:544
  ds_read_b64_tr_b16 v[52:53], v24 offset:576
  ds_read_b64_tr_b16 v[54:55], v24 offset:608
  ds_read_b64_tr_b16 v[56:57], v24 offset:640
  ds_read_b64_tr_b16 v[58:59], v24 offset:672
  ds_read_b64_tr_b16 v[60:61], v24 offset:704
  ds_read_b64_tr_b16 v[62:63], v24 offset:736
  s_waitcnt lgkmcnt(0)
  s_mov_b32 s46, 0x10001
  s_mov_b32 s47, 0x10001
  v_cndmask_b32 v88, 0, v36, s[46:47]
  v_cndmask_b32 v89, 0, v37, s[46:47]
  s_nop 1
  v_mfma_f32_16x16x16_bf16 v[116:119], v[88:89], v[40:41], v[116:119]
  s_mov_b32 s46, 0x20002
  s_mov_b32 s47, 0x20002
  v_cndmask_b32 v90, 0, v36, s[46:47]
  v_cndmask_b32 v91, 0, v37, s[46:47]
  s_nop 1
  v_mfma_f32_16x16x16_bf16 v[116:119], v[90:91], v[42:43], v[116:119]
  s_mov_b32 s46, 0x40004
  s_mov_b32 s47, 0x40004
  v_cndmask_b32 v88, 0, v36, s[46:47]
  v_cndmask_b32 v89, 0, v37, s[46:47]
  s_nop 1
  v_mfma_f32_16x16x16_bf16 v[116:119], v[88:89], v[44:45], v[116:119]
  s_mov_b32 s46, 0x100010
  s_mov_b32 s47, 0x100010
  v_cndmask_b32 v90, 0, v36, s[46:47]
  v_cndmask_b32 v91, 0, v37, s[46:47]
  s_nop 1
  v_mfma_f32_16x16x16_bf16 v[116:119], v[90:91], v[46:47], v[116:119]
  s_mov_b32 s46, 0x200020
  s_mov_b32 s47, 0x200020
  v_cndmask_b32 v88, 0, v36, s[46:47]
  v_cndmask_b32 v89, 0, v37, s[46:47]
  s_nop 1
  v_mfma_f32_16x16x16_bf16 v[116:119], v[88:89], v[48:49], v[116:119]
  s_mov_b32 s46, 0x400040
  s_mov_b32 s47, 0x400040
  v_cndmask_b32 v90, 0, v36, s[46:47]
  v_cndmask_b32 v91, 0, v37, s[46:47]
  s_nop 1
  v_mfma_f32_16x16x16_bf16 v[116:119], v[90:91], v[50:51], v[116:119]
  s_mov_b32 s46, 0x1000100
  s_mov_b32 s47, 0x1000100
  v_cndmask_b32 v88, 0, v36, s[46:47]
  v_cndmask_b32 v89, 0, v37, s[46:47]
  s_nop 1
  v_mfma_f32_16x16x16_bf16 v[116:119], v[88:89], v[52:53], v[116:119]
  s_mov_b32 s46, 0x2000200
  s_mov_b32 s47, 0x2000200
  v_cndmask_b32 v90, 0, v36, s[46:47]
  v_cndmask_b32 v91, 0, v37, s[46:47]
  s_nop 1
  v_mfma_f32_16x16x16_bf16 v[116:119], v[90:91], v[54:55], v[116:119]
  s_mov_b32 s46, 0x4000400
  s_mov_b32 s47, 0x4000400
  v_cndmask_b32 v88, 0, v36, s[46:47]
  v_cndmask_b32 v89, 0, v37, s[46:47]
  s_nop 1
  v_mfma_f32_16x16x16_bf16 v[116:119], v[88:89], v[56:57], v[116:119]
  s_mov_b32 s46, 0x10001000
  s_mov_b32 s47, 0x10001000
  v_cndmask_b32 v90, 0, v36, s[46:47]
  v_cndmask_b32 v91, 0, v37, s[46:47]
  s_nop 1
  v_mfma_f32_16x16x16_bf16 v[116:119], v[90:91], v[58:59], v[116:119]
  s_mov_b32 s46, 0x20002000
  s_mov_b32 s47, 0x20002000
  v_cndmask_b32 v88, 0, v36, s[46:47]
  v_cndmask_b32 v89, 0, v37, s[46:47]
  s_nop 1
  v_mfma_f32_16x16x16_bf16 v[116:119], v[88:89], v[60:61], v[116:119]
  s_mov_b32 s46, 0x40004000
  s_mov_b32 s47, 0x40004000
  v_cndmask_b32 v90, 0, v36, s[46:47]
  v_cndmask_b32 v91, 0, v37, s[46:47]
  s_nop 1
  v_mfma_f32_16x16x16_bf16 v[116:119], v[90:91], v[62:63], v[116:119]
  ds_read_b64_tr_b16 v[40:41], v24 offset:768
  ds_read_b64_tr_b16 v[42:43], v24 offset:800
  ds_read_b64_tr_b16 v[44:45], v24 offset:832
  ds_read_b64_tr_b16 v[46:47], v24 offset:864
  ds_read_b64_tr_b16 v[48:49], v24 offset:896
  ds_read_b64_tr_b16 v[50:51], v24 offset:928
  ds_read_b64_tr_b16 v[52:53], v24 offset:960
  ds_read_b64_tr_b16 v[54:55], v24 offset:992
  ds_read_b64_tr_b16 v[56:57], v24 offset:1024
  ds_read_b64_tr_b16 v[58:59], v24 offset:1056
  ds_read_b64_tr_b16 v[60:61], v24 offset:1088
  ds_read_b64_tr_b16 v[62:63], v24 offset:1120
  s_waitcnt lgkmcnt(0)
  s_mov_b32 s46, 0x10001
  s_mov_b32 s47, 0x10001
  v_cndmask_b32 v88, 0, v36, s[46:47]
  v_cndmask_b32 v89, 0, v37, s[46:47]
  s_nop 1
  v_mfma_f32_16x16x16_bf16 v[120:123], v[88:89], v[40:41], v[120:123]
  s_mov_b32 s46, 0x20002
  s_mov_b32 s47, 0x20002
  v_cndmask_b32 v90, 0, v36, s[46:47]
  v_cndmask_b32 v91, 0, v37, s[46:47]
  s_nop 1
  v_mfma_f32_16x16x16_bf16 v[120:123], v[90:91], v[42:43], v[120:123]
  s_mov_b32 s46, 0x40004
  s_mov_b32 s47, 0x40004
  v_cndmask_b32 v88, 0, v36, s[46:47]
  v_cndmask_b32 v89, 0, v37, s[46:47]
  s_nop 1
  v_mfma_f32_16x16x16_bf16 v[120:123], v[88:89], v[44:45], v[120:123]
  s_mov_b32 s46, 0x100010
  s_mov_b32 s47, 0x100010
  v_cndmask_b32 v90, 0, v36, s[46:47]
  v_cndmask_b32 v91, 0, v37, s[46:47]
  s_nop 1
  v_mfma_f32_16x16x16_bf16 v[120:123], v[90:91], v[46:47], v[120:123]
  s_mov_b32 s46, 0x200020
  s_mov_b32 s47, 0x200020
  v_cndmask_b32 v88, 0, v36, s[46:47]
  v_cndmask_b32 v89, 0, v37, s[46:47]
  s_nop 1
  v_mfma_f32_16x16x16_bf16 v[120:123], v[88:89], v[48:49], v[120:123]
  s_mov_b32 s46, 0x400040
  s_mov_b32 s47, 0x400040
  v_cndmask_b32 v90, 0, v36, s[46:47]
  v_cndmask_b32 v91, 0, v37, s[46:47]
  s_nop 1
  v_mfma_f32_16x16x16_bf16 v[120:123], v[90:91], v[50:51], v[120:123]
  s_mov_b32 s46, 0x1000100
  s_mov_b32 s47, 0x1000100
  v_cndmask_b32 v88, 0, v36, s[46:47]
  v_cndmask_b32 v89, 0, v37, s[46:47]
  s_nop 1
  v_mfma_f32_16x16x16_bf16 v[120:123], v[88:89], v[52:53], v[120:123]
  s_mov_b32 s46, 0x2000200
  s_mov_b32 s47, 0x2000200
  v_cndmask_b32 v90, 0, v36, s[46:47]
  v_cndmask_b32 v91, 0, v37, s[46:47]
  s_nop 1
  v_mfma_f32_16x16x16_bf16 v[120:123], v[90:91], v[54:55], v[120:123]
  s_mov_b32 s46, 0x4000400
  s_mov_b32 s47, 0x4000400
  v_cndmask_b32 v88, 0, v36, s[46:47]
  v_cndmask_b32 v89, 0, v37, s[46:47]
  s_nop 1
  v_mfma_f32_16x16x16_bf16 v[120:123], v[88:89], v[56:57], v[120:123]
  s_mov_b32 s46, 0x10001000
  s_mov_b32 s47, 0x10001000
  v_cndmask_b32 v90, 0, v36, s[46:47]
  v_cndmask_b32 v91, 0, v37, s[46:47]
  s_nop 1
  v_mfma_f32_16x16x16_bf16 v[120:123], v[90:91], v[58:59], v[120:123]
  s_mov_b32 s46, 0x20002000
  s_mov_b32 s47, 0x20002000
  v_cndmask_b32 v88, 0, v36, s[46:47]
  v_cndmask_b32 v89, 0, v37, s[46:47]
  s_nop 1
  v_mfma_f32_16x16x16_bf16 v[120:123], v[88:89], v[60:61], v[120:123]
  s_mov_b32 s46, 0x40004000
  s_mov_b32 s47, 0x40004000
  v_cndmask_b32 v90, 0, v36, s[46:47]
  v_cndmask_b32 v91, 0, v37, s[46:47]
  s_nop 1
  v_mfma_f32_16x16x16_bf16 v[120:123], v[90:91], v[62:63], v[120:123]
  s_add_u32 s59, s59, 1
  s_cmp_lt_u32 s59, 4
  s_cbranch_scc1 L_h_f2
  s_nop 7
  s_mul_i32 s40, s96, 3072
  s_add_u32 s40, s40, 229376
  s_add_u32 s48, s24, s40
  s_addc_u32 s49, s25, 0
  v_bitop3_b32 v115, v112, v113, v114 bitop3:0x96
  v_xor_b32 v115, s29, v115
  global_store_dwordx4 v23, v[112:115], s[48:49] offset:0 sc1
  v_bitop3_b32 v119, v116, v117, v118 bitop3:0x96
  v_xor_b32 v119, s29, v119
  global_store_dwordx4 v23, v[116:119], s[48:49] offset:1024 sc1
  v_bitop3_b32 v123, v120, v121, v122 bitop3:0x96
  v_xor_b32 v123, s29, v123
  global_store_dwordx4 v23, v[120:123], s[48:49] offset:2048 sc1
L_h_ffn_done:
  s_cmp_ge_u32 s97, 48
  s_cbranch_scc1 L_h_tail
  v_mov_b32 v34, 151552
  s_mov_b32 s42, 262144
L_h_fwait:
  ds_read_b32 v35, v34 offset:16
  s_waitcnt lgkmcnt(0)
  v_readfirstlane_b32 s40, v35
  s_cmp_ge_u32 s40, 32
  s_cbranch_scc1 L_h_fgo
  s_sleep 64
  s_sub_u32 s42, s42, 1
  s_cmp_lg_u32 s42, 0
  s_cbranch_scc1 L_h_fwait
L_h_fgo:
  s_lshl_b32 s40, s97, 6
  s_add_u32 s40, s40, 229376
  s_add_u32 s56, s24, s40
  s_addc_u32 s57, s25, 0
  v_lshrrev_b32 v30, 2, v1
  v_mul_u32_u24 v30, 3072, v30
  v_and_b32 v31, 3, v1
  v_lshl_add_u32 v30, v31, 4, v30
  v_add_u32 v31, 49152, v30
  v_add_u32 v32, 98304, v30
  v_add_u32 v33, 147456, v30
  v_add_u32 v34, 196608, v30
  s_mov_b32 s46, 0
  s_mov_b32 s47, -1
  v_add_u32 v35, 0xffffa000, v34
  v_cndmask_b32 v34, v34, v35, s[46:47]
  s_mov_b64 s[60:61], -1
  s_mov_b32 s63, 1
  s_mov_b32 s64, 262144
L_h_f_loop:
  s_bcnt1_i32_b64 s62, s[60:61]
  s_cmp_le_u32 s62, 8
  s_cselect_b32 s63, 1, s63
  s_mov_b64 exec, s[60:61]
  s_cmp_lg_u32 s63, 0
  s_cbranch_scc1 L_h_f_go
  s_ff1_i32_b64 s62, s[60:61]
  s_lshl_b64 exec, 1, s62
L_h_f_go:
  global_load_dwordx4 v[40:43], v30, s[56:57] sc1
  global_load_dwordx4 v[44:47], v31, s[56:57] sc1
  global_load_dwordx4 v[48:51], v32, s[56:57] sc1
  global_load_dwordx4 v[52:55], v33, s[56:57] sc1
  global_load_dwordx4 v[56:59], v34, s[56:57] sc1
  s_waitcnt vmcnt(0)
  v_bitop3_b32 v60, v40, v41, v42 bitop3:0x96
  v_bitop3_b32 v60, v60, v43, s29 bitop3:0x96
  v_bitop3_b32 v61, v44, v45, v46 bitop3:0x96
  v_bitop3_b32 v61, v61, v47, s29 bitop3:0x96
  v_or_b32 v60, v60, v61
  v_bitop3_b32 v61, v48, v49, v50 bitop3:0x96
  v_bitop3_b32 v61, v61, v51, s29 bitop3:0x96
  v_or_b32 v60, v60, v61
  v_bitop3_b32 v61, v52, v53, v54 bitop3:0x96
  v_bitop3_b32 v61, v61, v55, s29 bitop3:0x96
  v_or_b32 v60, v60, v61
  v_bitop3_b32 v61, v56, v57, v58 bitop3:0x96
  v_bitop3_b32 v61, v61, v59, s29 bitop3:0x96
  v_or_b32 v60, v60, v61
  v_cmp_eq_u32 vcc, 0, v60
  s_andn2_b64 s[60:61], s[60:61], vcc
  s_cmp_lg_u64 vcc, 0
  s_cselect_b32 s62, 1, 0
  s_xor_b32 s63, s63, 1
  s_and_b32 s63, s63, s62
  s_mov_b64 exec, -1
  s_cmp_eq_u64 s[60:61], 0
  s_cbranch_scc1 L_h_f_done
  s_bcnt1_i32_b64 s62, s[60:61]
  s_cmp_le_u32 s62, 8
  s_cbranch_scc1 L_h_f_ns
  s_sleep 32
L_h_f_ns:
  s_sub_u32 s64, s64, 1
  s_cmp_lg_u32 s64, 0
  s_cbranch_scc1 L_h_f_loop
L_h_f_done:
  s_mov_b32 s46, 0
  s_mov_b32 s47, -1
  v_cndmask_b32 v56, v56, 0, s[46:47]
  v_cndmask_b32 v57, v57, 0, s[46:47]
  v_cndmask_b32 v58, v58, 0, s[46:47]
  v_add_f32 v40, v40, v44
  v_add_f32 v48, v48, v52
  v_add_f32 v40, v40, v56
  v_add_f32 v41, v41, v45
  v_add_f32 v49, v49, v53
  v_add_f32 v41, v41, v57
  v_add_f32 v42, v42, v46
  v_add_f32 v50, v50, v54
  v_add_f32 v42, v42, v58
  v_add_f32 v40, v40, v48
  v_add_f32 v41, v41, v49
  v_add_f32 v42, v42, v50
  v_add_f32_dpp v40, v40, v40 row_ror:4 row_mask:0xf bank_mask:0xf
  v_add_f32_dpp v41, v41, v41 row_ror:4 row_mask:0xf bank_mask:0xf
  v_add_f32_dpp v42, v42, v42 row_ror:4 row_mask:0xf bank_mask:0xf
  v_add_f32_dpp v40, v40, v40 row_ror:8 row_mask:0xf bank_mask:0xf
  v_add_f32_dpp v41, v41, v41 row_ror:8 row_mask:0xf bank_mask:0xf
  v_add_f32_dpp v42, v42, v42 row_ror:8 row_mask:0xf bank_mask:0xf
  v_mov_b32 v44, v40
  v_mov_b32 v45, v41
  v_mov_b32 v46, v42
  s_nop 0
  v_permlane16_swap_b32 v40, v44
  v_permlane16_swap_b32 v41, v45
  v_permlane16_swap_b32 v42, v46
  v_add_f32 v40, v40, v44
  v_add_f32 v41, v41, v45
  v_add_f32 v42, v42, v46
  v_mov_b32 v44, v40
  v_mov_b32 v45, v41
  v_mov_b32 v46, v42
  s_branch L_pad_4_skip
L_pad_4:
  s_branch L_pad_5
L_pad_4_skip:
  s_nop 0
  v_permlane32_swap_b32 v40, v44
  v_permlane32_swap_b32 v41, v45
  v_permlane32_swap_b32 v42, v46
  v_add_f32 v40, v40, v44
  v_add_f32 v41, v41, v45
  v_add_f32 v42, v42, v46
  v_lshlrev_b32 v34, 4, v1
  v_add_u32 v34, 156800, v34
  s_mov_b64 exec, 15
  ds_write_b128 v34, v[40:43]
  s_mov_b64 exec, -1
L_h_tail:
  s_waitcnt vmcnt(0) lgkmcnt(0)
  v_lshrrev_b32 v30, 3, v1
  v_and_b32 v31, 7, v1
  v_min_u32 v32, 5, v31
  s_lshl_b32 s58, s27, 15
  v_lshlrev_b32 v33, 11, v30
  s_lshl_b32 s40, s28, 7
  s_add_u32 s58, s58, s40
  s_add_u32 s58, s58, 524288
  s_add_u32 s48, s24, s58
  s_addc_u32 s49, s25, 0
  v_lshl_add_u32 v34, v32, 4, v33
  v_add_u32 v35, 16384, v34
  v_add_u32 v36, 80, v33
  v_add_u32 v37, 16384, v36
  s_lshl_b32 s40, s27, 4
  s_add_u32 s40, s40, s28
  s_mul_i32 s40, s40, 2048
  s_add_u32 s40, s40, 524288
  s_add_u32 s56, s24, s40
  s_addc_u32 s57, s25, 0
  global_load_dwordx4 v[48:51], v23, s[56:57] offset:0 sc1
  global_load_dwordx4 v[52:55], v23, s[56:57] offset:1024 sc1
  s_lshl_b32 s40, s27, 4
  s_add_u32 s40, s40, s28
  s_mul_i32 s40, s40, 3072
  s_add_u32 s40, s40, 1048576
  s_add_u32 s56, s24, s40
  s_addc_u32 s57, s25, 0
  global_load_dwordx4 v[48:51], v23, s[56:57] offset:0 sc1
  global_load_dwordx4 v[52:55], v23, s[56:57] offset:1024 sc1
  global_load_dwordx4 v[56:59], v23, s[56:57] offset:2048 sc1
  s_waitcnt vmcnt(0)
  s_branch L_pad_0
L_chain2_done:
  v_mov_b32 v38, 151552
  s_mov_b32 s42, 262144
L_h_sw1:
  ds_read_b32 v44, v38 offset:52
  s_waitcnt lgkmcnt(0)
  v_readfirstlane_b32 s40, v44
  s_cmp_ge_u32 s40, 196
  s_cbranch_scc1 L_h_sw1_ok
  s_sleep 1
  s_sub_u32 s42, s42, 1
  s_cmp_lg_u32 s42, 0
  s_cbranch_scc1 L_h_sw1
L_h_sw1_ok:
  s_memrealtime s[50:51]
  s_lshl_b32 s40, s27, 8
  s_add_u32 s40, s40, 16384
  s_add_u32 s56, s24, s40
  s_addc_u32 s57, s25, 0
  s_lshl_b32 s58, s28, 4
  v_mov_b32 v39, s58
  s_waitcnt lgkmcnt(0)
  v_mov_b32 v40, s50
  v_mov_b32 v41, s98
  v_mov_b32 v42, 0
  v_bitop3_b32 v43, v40, v41, v42 bitop3:0x96
  v_xor_b32 v43, s29, v43
  s_mov_b64 exec, 1
  global_store_dwordx4 v39, v[40:43], s[56:57] sc1
  s_mov_b64 exec, -1
  s_mov_b32 s42, 262144
L_h_sw2:
  ds_read_b32 v44, v38 offset:52
  s_waitcnt lgkmcnt(0)
  v_readfirstlane_b32 s40, v44
  s_cmp_ge_u32 s40, 208
  s_cbranch_scc1 L_h_sw2_ok
  s_sleep 4
  s_sub_u32 s42, s42, 1
  s_cmp_lg_u32 s42, 0
  s_cbranch_scc1 L_h_sw2
L_h_sw2_ok:
  v_and_b32 v39, 15, v1
  v_lshlrev_b32 v39, 4, v39
  s_mov_b64 s[60:61], -1
  s_mov_b32 s63, 1
  s_mov_b32 s64, 262144
L_h_t_loop:
  s_bcnt1_i32_b64 s62, s[60:61]
  s_cmp_le_u32 s62, 64
  s_cselect_b32 s63, 1, s63
  s_mov_b64 exec, s[60:61]
  s_cmp_lg_u32 s63, 0
  s_cbranch_scc1 L_h_t_go
  s_ff1_i32_b64 s62, s[60:61]
  s_lshl_b64 exec, 1, s62
L_h_t_go:
  global_load_dwordx4 v[40:43], v39, s[56:57] sc1
  s_waitcnt vmcnt(0)
  v_bitop3_b32 v44, v40, v41, v42 bitop3:0x96
  v_bitop3_b32 v44, v44, v43, s29 bitop3:0x96
  v_cmp_eq_u32 vcc, 0, v44
  s_andn2_b64 s[60:61], s[60:61], vcc
  s_cmp_lg_u64 vcc, 0
  s_cselect_b32 s62, 1, 0
  s_xor_b32 s63, s63, 1
  s_and_b32 s63, s63, s62
  s_mov_b64 exec, -1
  s_cmp_eq_u64 s[60:61], 0
  s_cbranch_scc1 L_h_t_done
  s_bcnt1_i32_b64 s62, s[60:61]
  s_cmp_le_u32 s62, 8
  s_cbranch_scc1 L_h_t_ns
  s_sleep 4
L_h_t_ns:
  s_sub_u32 s64, s64, 1
  s_cmp_lg_u32 s64, 0
  s_cbranch_scc1 L_h_t_loop
L_h_t_done:
  v_readfirstlane_b32 s40, v40
  v_sub_u32 v45, v40, v41
  s_nop 0
  v_subrev_u32 v44, s40, v40
  v_cvt_f32_i32 v44, v44
  v_cvt_f32_u32 v45, v45
  v_mov_b32 v46, v44
  s_nop 1
  v_add_f32_dpp v46, v46, v46 row_ror:8 row_mask:0xf bank_mask:0xf
  s_nop 1
  v_add_f32_dpp v46, v46, v46 row_ror:4 row_mask:0xf bank_mask:0xf
  s_nop 1
  v_add_f32_dpp v46, v46, v46 row_ror:2 row_mask:0xf bank_mask:0xf
  s_nop 1
  v_add_f32_dpp v46, v46, v46 row_ror:1 row_mask:0xf bank_mask:0xf
  s_nop 1
  v_add_f32_dpp v45, v45, v45 row_ror:8 row_mask:0xf bank_mask:0xf
  s_nop 1
  v_add_f32_dpp v45, v45, v45 row_ror:4 row_mask:0xf bank_mask:0xf
  s_nop 1
  v_add_f32_dpp v45, v45, v45 row_ror:2 row_mask:0xf bank_mask:0xf
  s_nop 1
  v_add_f32_dpp v45, v45, v45 row_ror:1 row_mask:0xf bank_mask:0xf
  v_mul_f32 v46, 0x3d800000, v46
  v_mul_f32 v45, 0x399ba5e3, v45
  v_rcp_f32 v45, v45
  v_sub_f32 v46, v46, v44
  s_nop 0
  v_mul_f32 v46, v46, v45
  v_add_f32 v46, 0x41c00000, v46
  v_mov_b32 v48, v45
  v_max_f32 v46, 0, v46
  v_min_f32 v46, 0x42700000, v46
  v_mov_b32 v47, v46
  s_nop 1
  v_add_f32_dpp v47, v47, v47 row_ror:8 row_mask:0xf bank_mask:0xf
  s_nop 1
  v_add_f32_dpp v47, v47, v47 row_ror:4 row_mask:0xf bank_mask:0xf
  s_nop 1
  v_add_f32_dpp v47, v47, v47 row_ror:2 row_mask:0xf bank_mask:0xf
  s_nop 1
  v_add_f32_dpp v47, v47, v47 row_ror:1 row_mask:0xf bank_mask:0xf
  v_rcp_f32 v47, v47
  s_nop 0
  v_mul_f32 v47, 0x43c00000, v47
  v_mul_f32 v46, v46, v47
  s_nop 1
  v_add_f32_dpp v46, v46, v46 row_shr:1 row_mask:0xf bank_mask:0xf bound_ctrl:0
  s_nop 1
  v_add_f32_dpp v46, v46, v46 row_shr:2 row_mask:0xf bank_mask:0xf bound_ctrl:0
  s_nop 1
  v_add_f32_dpp v46, v46, v46 row_shr:4 row_mask:0xf bank_mask:0xf bound_ctrl:0
  s_nop 1
  v_add_f32_dpp v46, v46, v46 row_shr:8 row_mask:0xf bank_mask:0xf bound_ctrl:0
  v_add_f32 v46, 0.5, v46
  v_cvt_i32_f32 v46, v46
  v_min_i32 v46, 384, v46
  v_max_i32 v46, 0, v46
  s_nop 1
  v_max_i32_dpp v46, v46, v46 row_shr:1 row_mask:0xf bank_mask:0xf bound_ctrl:0
  s_nop 1
  v_max_i32_dpp v46, v46, v46 row_shr:2 row_mask:0xf bank_mask:0xf bound_ctrl:0
  s_nop 1
  v_max_i32_dpp v46, v46, v46 row_shr:4 row_mask:0xf bank_mask:0xf bound_ctrl:0
  s_nop 1
  v_max_i32_dpp v46, v46, v46 row_shr:8 row_mask:0xf bank_mask:0xf bound_ctrl:0
  s_mov_b32 s50, 0x80008000
  s_mov_b32 s51, 0x80008000
  v_mov_b32 v47, 384
  v_cndmask_b32 v46, v46, v47, s[50:51]
  v_mov_b32 v47, 0
  s_nop 1
  v_mov_b32_dpp v47, v46 row_shr:1 row_mask:0xf bank_mask:0xf bound_ctrl:0
  v_sub_u32 v46, v46, v47
  s_mov_b32 s55, 0
  v_sub_u32 v49, 24, v46
  v_subrev_u32 v50, 24, v46
  v_max_i32 v49, 0, v49
  v_max_i32 v50, 0, v50
  v_mov_b32 v51, v49
  v_mov_b32 v52, v50
  s_nop 0
  v_add_u32_dpp v51, v51, v51 row_shr:1 row_mask:0xf bank_mask:0xf bound_ctrl:0
  v_add_u32_dpp v52, v52, v52 row_shr:1 row_mask:0xf bank_mask:0xf bound_ctrl:0
  s_nop 0
  v_add_u32_dpp v51, v51, v51 row_shr:2 row_mask:0xf bank_mask:0xf bound_ctrl:0
  v_add_u32_dpp v52, v52, v52 row_shr:2 row_mask:0xf bank_mask:0xf bound_ctrl:0
  s_nop 0
  v_add_u32_dpp v51, v51, v51 row_shr:4 row_mask:0xf bank_mask:0xf bound_ctrl:0
  v_add_u32_dpp v52, v52, v52 row_shr:4 row_mask:0xf bank_mask:0xf bound_ctrl:0
  s_nop 0
  v_add_u32_dpp v51, v51, v51 row_shr:8 row_mask:0xf bank_mask:0xf bound_ctrl:0
  v_add_u32_dpp v52, v52, v52 row_shr:8 row_mask:0xf bank_mask:0xf bound_ctrl:0
  v_sub_u32 v53, v51, v49
  v_sub_u32 v52, v52, v50
  s_nop 0
  v_readlane_b32 s50, v46, s28
  v_readlane_b32 s51, v52, s28
  v_readlane_b32 s30, v51, 0
  v_readlane_b32 s31, v51, 1
  v_readlane_b32 s32, v51, 2
  v_readlane_b32 s33, v51, 3
  v_readlane_b32 s34, v51, 4
  v_readlane_b32 s35, v51, 5
  v_readlane_b32 s36, v51, 6
  v_readlane_b32 s37, v51, 7
  v_readlane_b32 s40, v51, 8
  v_readlane_b32 s41, v51, 9
  v_readlane_b32 s43, v51, 10
  v_readlane_b32 s44, v51, 11
  v_readlane_b32 s45, v51, 12
  v_readlane_b32 s46, v51, 13
  v_readlane_b32 s47, v51, 14
  v_readlane_b32 s53, v51, 15
  s_branch L_pad_5_skip
L_pad_5:
  s_branch L_pad_6
L_pad_5_skip:
  s_mul_i32 s54, s27, 512
  s_sub_u32 s51, s51, 24
  s_mov_b32 s52, 0
L_h_tba:
  v_add_u32 v54, s52, v1
  v_add_u32 v55, s51, v54
  v_mov_b32 v56, 0
  v_cmp_le_u32 vcc, s30, v55
  v_cmp_le_u32 s[58:59], s31, v55
  v_cmp_le_u32 s[60:61], s32, v55
  v_cmp_le_u32 s[62:63], s33, v55
  v_addc_co_u32 v56, vcc, 0, v56, vcc
  v_addc_co_u32 v56, s[58:59], 0, v56, s[58:59]
  v_addc_co_u32 v56, s[60:61], 0, v56, s[60:61]
  v_addc_co_u32 v56, s[62:63], 0, v56, s[62:63]
  v_cmp_le_u32 vcc, s34, v55
  v_cmp_le_u32 s[58:59], s35, v55
  v_cmp_le_u32 s[60:61], s36, v55
  v_cmp_le_u32 s[62:63], s37, v55
  v_addc_co_u32 v56, vcc, 0, v56, vcc
  v_addc_co_u32 v56, s[58:59], 0, v56, s[58:59]
  v_addc_co_u32 v56, s[60:61], 0, v56, s[60:61]
  v_addc_co_u32 v56, s[62:63], 0, v56, s[62:63]
  v_cmp_le_u32 vcc, s40, v55
  v_cmp_le_u32 s[58:59], s41, v55
  v_cmp_le_u32 s[60:61], s43, v55
  v_cmp_le_u32 s[62:63], s44, v55
  v_addc_co_u32 v56, vcc, 0, v56, vcc
  v_addc_co_u32 v56, s[58:59], 0, v56, s[58:59]
  v_addc_co_u32 v56, s[60:61], 0, v56, s[60:61]
  v_addc_co_u32 v56, s[62:63], 0, v56, s[62:63]
  v_cmp_le_u32 vcc, s45, v55
  v_cmp_le_u32 s[58:59], s46, v55
  v_cmp_le_u32 s[60:61], s47, v55
  v_cmp_le_u32 s[62:63], s53, v55
  v_addc_co_u32 v56, vcc, 0, v56, vcc
  v_addc_co_u32 v56, s[58:59], 0, v56, s[58:59]
  v_addc_co_u32 v56, s[60:61], 0, v56, s[60:61]
  v_addc_co_u32 v56, s[62:63], 0, v56, s[62:63]
  v_min_u32 v56, 15, v56
  v_lshlrev_b32 v57, 2, v56
  ds_bpermute_b32 v58, v57, v53
  ds_bpermute_b32 v59, v57, v46
  v_cmp_gt_u32 vcc, 24, v54
  v_mov_b32 v57, s28
  s_waitcnt lgkmcnt(0)
  v_add_u32 v59, v59, v55
  v_sub_u32 v59, v59, v58
  v_cndmask_b32 v56, v56, v57, vcc
  v_cndmask_b32 v59, v59, v54, vcc
  v_add_u32 v59, 224, v59
  v_lshrrev_b32 v57, 3, v59
  v_lshlrev_b32 v57, 7, v57
  v_and_b32 v58, 7, v56
  v_lshrrev_b32 v56, 3, v56
  v_lshl_add_u32 v56, v58, 1, v56
  v_lshl_add_u32 v57, v56, 3, v57
  v_and_b32 v59, 7, v59
  v_add_u32 v57, v57, v59
  v_add_u32 v57, s54, v57
  v_and_b32 v57, 4095, v57
  v_add_u32 v57, 1, v57
  s_mov_b32 s56, s50
  s_min_u32 s56, s56, 388
  v_add_u32 v58, s55, v54
  v_lshlrev_b32 v58, 2, v58
  v_add_u32 v58, 156928, v58
  v_cmp_gt_u32 vcc, s56, v54
  s_and_saveexec_b64 s[58:59], vcc
  ds_write_b32 v58, v57
  s_mov_b64 exec, -1
  s_add_u32 s52, s52, 64
  s_cmp_lt_u32 s52, s56
  s_cbranch_scc1 L_h_tba
  s_mov_b32 s55, s50
  s_add_u32 s50, s50, 1
  s_add_u32 s58, s50, 207
  s_mov_b32 s42, 262144
L_h_s2a:
  ds_read_b32 v44, v38 offset:52
  s_waitcnt lgkmcnt(0)
  v_readfirstlane_b32 s40, v44
  s_cmp_ge_u32 s40, s58
  s_cbranch_scc1 L_h_s2a_ok
  s_sleep 2
  s_sub_u32 s42, s42, 1
  s_cmp_lg_u32 s42, 0
  s_cbranch_scc1 L_h_s2a
L_h_s2a_ok:
  s_memrealtime s[56:57]
  s_add_u32 s59, s50, 219
  s_sub_i32 s59, s59, s40
  s_max_i32 s59, s59, 0
  s_waitcnt lgkmcnt(0)
  v_mov_b32 v40, s56
  v_mov_b32 v41, s59
  v_mov_b32 v42, 0
  s_lshl_b32 s40, s27, 8
  s_add_u32 s40, s40, 24576
  s_add_u32 s56, s24, s40
  s_addc_u32 s57, s25, 0
  s_lshl_b32 s59, s28, 4
  v_mov_b32 v39, s59
  v_bitop3_b32 v43, v40, v41, v42 bitop3:0x96
  v_xor_b32 v43, s29, v43
  s_mov_b64 exec, 1
  global_store_dwordx4 v39, v[40:43], s[56:57] sc1
  s_mov_b64 exec, -1
  s_add_u32 s58, s58, 5
  s_mov_b32 s42, 262144
L_h_s2b:
  ds_read_b32 v44, v38 offset:52
  s_waitcnt lgkmcnt(0)
  v_readfirstlane_b32 s40, v44
  s_cmp_ge_u32 s40, s58
  s_cbranch_scc1 L_h_s2b_ok
  s_sleep 2
  s_sub_u32 s42, s42, 1
  s_cmp_lg_u32 s42, 0
  s_cbranch_scc1 L_h_s2b
L_h_s2b_ok:
  v_and_b32 v39, 15, v1
  v_lshlrev_b32 v39, 4, v39
  s_mov_b64 s[60:61], -1
  s_mov_b32 s63, 1
  s_mov_b32 s64, 262144
L_h_t2_loop:
  s_bcnt1_i32_b64 s62, s[60:61]
  s_cmp_le_u32 s62, 64
  s_cselect_b32 s63, 1, s63
  s_mov_b64 exec, s[60:61]
  s_cmp_lg_u32 s63, 0
  s_cbranch_scc1 L_h_t2_go
  s_ff1_i32_b64 s62, s[60:61]
  s_lshl_b64 exec, 1, s62
L_h_t2_go:
  global_load_dwordx4 v[40:43], v39, s[56:57] sc1
  s_waitcnt vmcnt(0)
  v_bitop3_b32 v44, v40, v41, v42 bitop3:0x96
  v_bitop3_b32 v44, v44, v43, s29 bitop3:0x96
  v_cmp_eq_u32 vcc, 0, v44
  s_andn2_b64 s[60:61], s[60:61], vcc
  s_cmp_lg_u64 vcc, 0
  s_cselect_b32 s62, 1, 0
  s_xor_b32 s63, s63, 1
  s_and_b32 s63, s63, s62
  s_mov_b64 exec, -1
  s_cmp_eq_u64 s[60:61], 0
  s_cbranch_scc1 L_h_t2_done
  s_bcnt1_i32_b64 s62, s[60:61]
  s_cmp_le_u32 s62, 8
  s_cbranch_scc1 L_h_t2_ns
  s_sleep 2
L_h_t2_ns:
  s_sub_u32 s64, s64, 1
  s_cmp_lg_u32 s64, 0
  s_cbranch_scc1 L_h_t2_loop
L_h_t2_done:
  v_readfirstlane_b32 s40, v40
  v_cvt_f32_u32 v45, v41
  s_nop 0
  v_subrev_u32 v44, s40, v40
  v_cvt_f32_i32 v44, v44
  v_mul_f32 v44, v44, v48
  v_mul_f32 v44, 0x3f800000, v44
  v_add_f32 v44, v44, v45
  v_mov_b32 v46, v44
  s_nop 1
  v_add_f32_dpp v46, v46, v46 row_ror:8 row_mask:0xf bank_mask:0xf
  s_nop 1
  v_add_f32_dpp v46, v46, v46 row_ror:4 row_mask:0xf bank_mask:0xf
  s_nop 1
  v_add_f32_dpp v46, v46, v46 row_ror:2 row_mask:0xf bank_mask:0xf
  s_nop 1
  v_add_f32_dpp v46, v46, v46 row_ror:1 row_mask:0xf bank_mask:0xf
  v_mul_f32 v46, 0x3d800000, v46
  v_sub_f32 v46, v46, v44
  v_add_f32 v46, 0x41000000, v46
  v_max_f32 v46, 0, v46
  v_min_f32 v46, 0x41a00000, v46
  v_mov_b32 v47, v46
  s_nop 1
  v_add_f32_dpp v47, v47, v47 row_ror:8 row_mask:0xf bank_mask:0xf
  s_nop 1
  v_add_f32_dpp v47, v47, v47 row_ror:4 row_mask:0xf bank_mask:0xf
  s_nop 1
  v_add_f32_dpp v47, v47, v47 row_ror:2 row_mask:0xf bank_mask:0xf
  s_nop 1
  v_add_f32_dpp v47, v47, v47 row_ror:1 row_mask:0xf bank_mask:0xf
  v_rcp_f32 v47, v47
  s_nop 0
  v_mul_f32 v47, 0x43000000, v47
  v_mul_f32 v46, v46, v47
  s_nop 1
  v_add_f32_dpp v46, v46, v46 row_shr:1 row_mask:0xf bank_mask:0xf bound_ctrl:0
  s_nop 1
  v_add_f32_dpp v46, v46, v46 row_shr:2 row_mask:0xf bank_mask:0xf bound_ctrl:0
  s_nop 1
  v_add_f32_dpp v46, v46, v46 row_shr:4 row_mask:0xf bank_mask:0xf bound_ctrl:0
  s_nop 1
  v_add_f32_dpp v46, v46, v46 row_shr:8 row_mask:0xf bank_mask:0xf bound_ctrl:0
  v_add_f32 v46, 0.5, v46
  v_cvt_i32_f32 v46, v46
  v_min_i32 v46, 128, v46
  v_max_i32 v46, 0, v46
  s_nop 1
  v_max_i32_dpp v46, v46, v46 row_shr:1 row_mask:0xf bank_mask:0xf bound_ctrl:0
  s_nop 1
  v_max_i32_dpp v46, v46, v46 row_shr:2 row_mask:0xf bank_mask:0xf bound_ctrl:0
  s_nop 1
  v_max_i32_dpp v46, v46, v46 row_shr:4 row_mask:0xf bank_mask:0xf bound_ctrl:0
  s_nop 1
  v_max_i32_dpp v46, v46, v46 row_shr:8 row_mask:0xf bank_mask:0xf bound_ctrl:0
  s_mov_b32 s50, 0x80008000
  s_mov_b32 s51, 0x80008000
  v_mov_b32 v47, 128
  v_cndmask_b32 v46, v46, v47, s[50:51]
  v_mov_b32 v47, 0
  s_nop 1
  v_mov_b32_dpp v47, v46 row_shr:1 row_mask:0xf bank_mask:0xf bound_ctrl:0
  v_sub_u32 v46, v46, v47
  v_sub_u32 v49, 8, v46
  v_subrev_u32 v50, 8, v46
  v_max_i32 v49, 0, v49
  v_max_i32 v50, 0, v50
  v_mov_b32 v51, v49
  v_mov_b32 v52, v50
  s_nop 0
  v_add_u32_dpp v51, v51, v51 row_shr:1 row_mask:0xf bank_mask:0xf bound_ctrl:0
  v_add_u32_dpp v52, v52, v52 row_shr:1 row_mask:0xf bank_mask:0xf bound_ctrl:0
  s_nop 0
  v_add_u32_dpp v51, v51, v51 row_shr:2 row_mask:0xf bank_mask:0xf bound_ctrl:0
  v_add_u32_dpp v52, v52, v52 row_shr:2 row_mask:0xf bank_mask:0xf bound_ctrl:0
  s_nop 0
  v_add_u32_dpp v51, v51, v51 row_shr:4 row_mask:0xf bank_mask:0xf bound_ctrl:0
  v_add_u32_dpp v52, v52, v52 row_shr:4 row_mask:0xf bank_mask:0xf bound_ctrl:0
  s_nop 0
  v_add_u32_dpp v51, v51, v51 row_shr:8 row_mask:0xf bank_mask:0xf bound_ctrl:0
  v_add_u32_dpp v52, v52, v52 row_shr:8 row_mask:0xf bank_mask:0xf bound_ctrl:0
  v_sub_u32 v53, v51, v49
  v_sub_u32 v52, v52, v50
  s_nop 0
  v_readlane_b32 s50, v46, s28
  v_readlane_b32 s51, v52, s28
  s_branch L_pad_6_skip
L_pad_6:
  s_branch L_pad_10
L_pad_6_skip:
  v_readlane_b32 s30, v51, 0
  v_readlane_b32 s31, v51, 1
  v_readlane_b32 s32, v51, 2
  v_readlane_b32 s33, v51, 3
  v_readlane_b32 s34, v51, 4
  v_readlane_b32 s35, v51, 5
  v_readlane_b32 s36, v51, 6
  v_readlane_b32 s37, v51, 7
  v_readlane_b32 s40, v51, 8
  v_readlane_b32 s41, v51, 9
  v_readlane_b32 s43, v51, 10
  v_readlane_b32 s44, v51, 11
  v_readlane_b32 s45, v51, 12
  v_readlane_b32 s46, v51, 13
  v_readlane_b32 s47, v51, 14
  v_readlane_b32 s53, v51, 15
  s_mul_i32 s54, s27, 512
  s_sub_u32 s51, s51, 8
  s_mov_b32 s52, 0
L_h_tbb:
  v_add_u32 v54, s52, v1
  v_add_u32 v55, s51, v54
  v_mov_b32 v56, 0
  v_cmp_le_u32 vcc, s30, v55
  v_cmp_le_u32 s[58:59], s31, v55
  v_cmp_le_u32 s[60:61], s32, v55
  v_cmp_le_u32 s[62:63], s33, v55
  v_addc_co_u32 v56, vcc, 0, v56, vcc
  v_addc_co_u32 v56, s[58:59], 0, v56, s[58:59]
  v_addc_co_u32 v56, s[60:61], 0, v56, s[60:61]
  v_addc_co_u32 v56, s[62:63], 0, v56, s[62:63]
  v_cmp_le_u32 vcc, s34, v55
  v_cmp_le_u32 s[58:59], s35, v55
  v_cmp_le_u32 s[60:61], s36, v55
  v_cmp_le_u32 s[62:63], s37, v55
  v_addc_co_u32 v56, vcc, 0, v56, vcc
  v_addc_co_u32 v56, s[58:59], 0, v56, s[58:59]
  v_addc_co_u32 v56, s[60:61], 0, v56, s[60:61]
  v_addc_co_u32 v56, s[62:63], 0, v56, s[62:63]
  v_cmp_le_u32 vcc, s40, v55
  v_cmp_le_u32 s[58:59], s41, v55
  v_cmp_le_u32 s[60:61], s43, v55
  v_cmp_le_u32 s[62:63], s44, v55
  v_addc_co_u32 v56, vcc, 0, v56, vcc
  v_addc_co_u32 v56, s[58:59], 0, v56, s[58:59]
  v_addc_co_u32 v56, s[60:61], 0, v56, s[60:61]
  v_addc_co_u32 v56, s[62:63], 0, v56, s[62:63]
  v_cmp_le_u32 vcc, s45, v55
  v_cmp_le_u32 s[58:59], s46, v55
  v_cmp_le_u32 s[60:61], s47, v55
  v_cmp_le_u32 s[62:63], s53, v55
  v_addc_co_u32 v56, vcc, 0, v56, vcc
  v_addc_co_u32 v56, s[58:59], 0, v56, s[58:59]
  v_addc_co_u32 v56, s[60:61], 0, v56, s[60:61]
  v_addc_co_u32 v56, s[62:63], 0, v56, s[62:63]
  v_min_u32 v56, 15, v56
  v_lshlrev_b32 v57, 2, v56
  ds_bpermute_b32 v58, v57, v53
  ds_bpermute_b32 v59, v57, v46
  v_cmp_gt_u32 vcc, 8, v54
  v_mov_b32 v57, s28
  s_waitcnt lgkmcnt(0)
  v_add_u32 v59, v59, v55
  v_sub_u32 v59, v59, v58
  v_cndmask_b32 v56, v56, v57, vcc
  v_cndmask_b32 v59, v59, v54, vcc
  v_add_u32 v59, 248, v59
  v_lshrrev_b32 v57, 3, v59
  v_lshlrev_b32 v57, 7, v57
  v_and_b32 v58, 7, v56
  v_lshrrev_b32 v56, 3, v56
  v_lshl_add_u32 v56, v58, 1, v56
  v_lshl_add_u32 v57, v56, 3, v57
  v_and_b32 v59, 7, v59
  v_add_u32 v57, v57, v59
  v_add_u32 v57, s54, v57
  v_and_b32 v57, 4095, v57
  v_add_u32 v57, 1, v57
  v_add_u32 v58, 8, v54
  v_cmp_le_u32 vcc, s50, v58
  v_cmp_le_u32 s[60:61], s50, v54
  v_or_b32 v58, 0x40000000, v57
  v_bfrev_b32 v59, 1
  v_cndmask_b32 v57, v57, v58, vcc
  v_cndmask_b32 v57, v57, v59, s[60:61]
  s_add_u32 s56, s50, 4
  s_min_u32 s56, s56, 132
  v_add_u32 v58, s55, v54
  v_lshlrev_b32 v58, 2, v58
  v_add_u32 v58, 156928, v58
  v_cmp_gt_u32 vcc, s56, v54
  s_and_saveexec_b64 s[58:59], vcc
  ds_write_b32 v58, v57
  s_mov_b64 exec, -1
  s_add_u32 s52, s52, 64
  s_cmp_lt_u32 s52, s56
  s_cbranch_scc1 L_h_tbb
  s_add_u32 s50, s50, 1
  s_mov_b32 s50, 1
  s_add_u32 s50, s50, 210
  s_mov_b32 s42, 262144
L_h_sw3:
  ds_read_b32 v44, v38 offset:52
  s_waitcnt lgkmcnt(0)
  v_readfirstlane_b32 s40, v44
  s_cmp_ge_u32 s40, s50
  s_cbranch_scc1 L_h_sw3_ok
  s_sleep 4
  s_sub_u32 s42, s42, 1
  s_cmp_lg_u32 s42, 0
  s_cbranch_scc1 L_h_sw3
L_h_sw3_ok:
  v_mul_u32_u24 v39, 6, v31
  v_add_u32 v39, 156032, v39
  s_barrier
  s_mov_b64 s[60:61], -1
  s_mov_b32 s63, 1
  s_mov_b32 s64, 262144
L_h_b_loop:
  s_mov_b64 exec, s[60:61]
  s_cmp_lg_u32 s63, 0
  s_cbranch_scc1 L_h_b_go
  s_ff1_i32_b64 s62, s[60:61]
  s_lshl_b64 exec, 1, s62
L_h_b_go:
  global_load_dwordx4 v[40:43], v34, s[48:49] sc1
  global_load_dwordx4 v[44:47], v35, s[48:49] sc1
  global_load_dwordx4 v[48:51], v36, s[48:49] sc1
  global_load_dwordx4 v[52:55], v37, s[48:49] sc1
  s_waitcnt vmcnt(0)
  v_bitop3_b32 v56, v40, v41, v42 bitop3:0x96
  v_bitop3_b32 v56, v56, v43, s29 bitop3:0x96
  v_bitop3_b32 v57, v44, v45, v46 bitop3:0x96
  v_bitop3_b32 v57, v57, v47, s29 bitop3:0x96
  v_or_b32 v56, v56, v57
  v_bitop3_b32 v57, v48, v49, v50 bitop3:0x96
  v_bitop3_b32 v57, v57, v51, s29 bitop3:0x96
  v_or_b32 v56, v56, v57
  v_bitop3_b32 v57, v52, v53, v54 bitop3:0x96
  v_bitop3_b32 v57, v57, v55, s29 bitop3:0x96
  v_or_b32 v56, v56, v57
  v_cmp_eq_u32 vcc, 0, v56
  s_andn2_b64 s[60:61], s[60:61], vcc
  s_cmp_lg_u64 vcc, 0
  s_cselect_b32 s62, 1, 0
  s_xor_b32 s63, s63, 1
  s_and_b32 s63, s63, s62
  s_mov_b64 exec, -1
  s_cmp_eq_u64 s[60:61], 0
  s_cbranch_scc1 L_h_b_done
  s_bcnt1_i32_b64 s62, s[60:61]
  s_cmp_le_u32 s62, 64
  s_cbranch_scc1 L_h_b_p2
  s_sleep 2
  s_sub_u32 s64, s64, 1
  s_cmp_lg_u32 s64, 0
  s_cbranch_scc1 L_h_b_loop
  s_branch L_h_b_done
L_h_b_p2:
  s_mov_b64 exec, s[60:61]
  global_load_dwordx4 v[40:43], v34, s[48:49] sc1
  global_load_dwordx4 v[44:47], v35, s[48:49] sc1
  global_load_dwordx4 v[48:51], v36, s[48:49] sc1
  global_load_dwordx4 v[52:55], v37, s[48:49] sc1
  s_sleep 8
  global_load_dwordx4 v[68:71], v34, s[48:49] sc1
  global_load_dwordx4 v[72:75], v35, s[48:49] sc1
  global_load_dwordx4 v[76:79], v36, s[48:49] sc1
  global_load_dwordx4 v[80:83], v37, s[48:49] sc1
L_h_b_p2l:
  s_waitcnt vmcnt(4)
  v_bitop3_b32 v56, v40, v41, v42 bitop3:0x96
  v_bitop3_b32 v56, v56, v43, s29 bitop3:0x96
  v_bitop3_b32 v57, v44, v45, v46 bitop3:0x96
  v_bitop3_b32 v57, v57, v47, s29 bitop3:0x96
  v_or_b32 v56, v56, v57
  v_bitop3_b32 v57, v48, v49, v50 bitop3:0x96
  v_bitop3_b32 v57, v57, v51, s29 bitop3:0x96
  v_or_b32 v56, v56, v57
  v_bitop3_b32 v57, v52, v53, v54 bitop3:0x96
  v_bitop3_b32 v57, v57, v55, s29 bitop3:0x96
  v_or_b32 v56, v56, v57
  v_cmp_eq_u32 vcc, 0, v56
  s_and_b64 vcc, vcc, s[60:61]
  s_andn2_b64 s[60:61], s[60:61], vcc
  s_cmp_eq_u64 s[60:61], 0
  s_cbranch_scc1 L_h_b_done
  s_mov_b64 exec, s[60:61]
  global_load_dwordx4 v[40:43], v34, s[48:49] sc1
  global_load_dwordx4 v[44:47], v35, s[48:49] sc1
  global_load_dwordx4 v[48:51], v36, s[48:49] sc1
  global_load_dwordx4 v[52:55], v37, s[48:49] sc1
  s_waitcnt vmcnt(4)
  v_bitop3_b32 v56, v68, v69, v70 bitop3:0x96
  v_bitop3_b32 v56, v56, v71, s29 bitop3:0x96
  v_bitop3_b32 v57, v72, v73, v74 bitop3:0x96
  v_bitop3_b32 v57, v57, v75, s29 bitop3:0x96
  v_or_b32 v56, v56, v57
  v_bitop3_b32 v57, v76, v77, v78 bitop3:0x96
  v_bitop3_b32 v57, v57, v79, s29 bitop3:0x96
  v_or_b32 v56, v56, v57
  v_bitop3_b32 v57, v80, v81, v82 bitop3:0x96
  v_bitop3_b32 v57, v57, v83, s29 bitop3:0x96
  v_or_b32 v56, v56, v57
  v_cmp_eq_u32 vcc, 0, v56
  s_and_b64 vcc, vcc, s[60:61]
  s_mov_b64 exec, vcc
  v_mov_b32 v40, v68
  v_mov_b32 v41, v69
  v_mov_b32 v42, v70
  v_mov_b32 v44, v72
  v_mov_b32 v45, v73
  v_mov_b32 v46, v74
  v_mov_b32 v48, v76
  v_mov_b32 v49, v77
  v_mov_b32 v50, v78
  v_mov_b32 v52, v80
  v_mov_b32 v53, v81
  v_mov_b32 v54, v82
  s_andn2_b64 s[60:61], s[60:61], vcc
  s_cmp_eq_u64 s[60:61], 0
  s_cbranch_scc1 L_h_b_done
  s_mov_b64 exec, s[60:61]
  global_load_dwordx4 v[68:71], v34, s[48:49] sc1
  global_load_dwordx4 v[72:75], v35, s[48:49] sc1
  global_load_dwordx4 v[76:79], v36, s[48:49] sc1
  global_load_dwordx4 v[80:83], v37, s[48:49] sc1
  s_sub_u32 s64, s64, 1
  s_cmp_lg_u32 s64, 0
  s_cbranch_scc1 L_h_b_p2l
L_h_b_done:
  s_mov_b64 exec, -1
  v_max_f32 v56, v49, v53
  s_nop 1
  v_max_f32_dpp v56, v56, v56 row_ror:8 row_mask:0xf bank_mask:0xf
  v_mov_b32 v57, v56
  s_nop 1
  v_permlane16_swap_b32 v56, v57
  s_nop 1
  v_max_f32 v56, v56, v57
  v_mov_b32 v57, v56
  s_nop 1
  v_permlane32_swap_b32 v56, v57
  s_nop 1
  v_max_f32 v56, v56, v57
  v_sub_f32 v58, v49, v56
  v_sub_f32 v59, v53, v56
  v_exp_f32 v58, v58
  v_exp_f32 v59, v59
  s_nop 0
  v_mul_f32 v60, v50, v58
  v_mul_f32 v61, v40, v58
  v_mul_f32 v62, v41, v58
  v_mul_f32 v63, v42, v58
  v_fmac_f32 v60, v54, v59
  v_fmac_f32 v61, v44, v59
  v_fmac_f32 v62, v45, v59
  v_fmac_f32 v63, v46, v59
  v_add_f32_dpp v60, v60, v60 row_ror:8 row_mask:0xf bank_mask:0xf
  v_add_f32_dpp v61, v61, v61 row_ror:8 row_mask:0xf bank_mask:0xf
  v_add_f32_dpp v62, v62, v62 row_ror:8 row_mask:0xf bank_mask:0xf
  v_add_f32_dpp v63, v63, v63 row_ror:8 row_mask:0xf bank_mask:0xf
  v_mov_b32 v84, v60
  v_mov_b32 v85, v61
  v_mov_b32 v86, v62
  v_mov_b32 v87, v63
  s_nop 0
  v_permlane16_swap_b32 v60, v84
  v_permlane16_swap_b32 v61, v85
  v_permlane16_swap_b32 v62, v86
  v_permlane16_swap_b32 v63, v87
  v_add_f32 v60, v60, v84
  v_add_f32 v61, v61, v85
  v_add_f32 v62, v62, v86
  v_add_f32 v63, v63, v87
  v_mov_b32 v84, v60
  v_mov_b32 v85, v61
  v_mov_b32 v86, v62
  v_mov_b32 v87, v63
  s_nop 0
  v_permlane32_swap_b32 v60, v84
  v_permlane32_swap_b32 v61, v85
  v_permlane32_swap_b32 v62, v86
  v_permlane32_swap_b32 v63, v87
  v_add_f32 v60, v60, v84
  v_add_f32 v61, v61, v85
  v_add_f32 v62, v62, v86
  v_add_f32 v63, v63, v87
  v_rcp_f32 v64, v60
  s_nop 0
  v_mul_f32 v56, v61, v64
  v_mul_f32 v57, v62, v64
  v_mul_f32 v58, v63, v64
  v_fma_f32 v61, -v56, v60, v61
  v_fma_f32 v62, -v57, v60, v62
  v_fma_f32 v63, -v58, v60, v63
  v_fma_f32 v61, v61, v64, v56
  v_fma_f32 v62, v62, v64, v57
  v_fma_f32 v63, v63, v64, v58
  v_cvt_pk_bf16_f32 v61, v61, v62
  v_cvt_pk_bf16_f32 v63, v63, v63
  v_mov_b32 v62, v39
  s_mov_b64 exec, 0x3f
  ds_write_b16 v62, v61
  s_mov_b64 exec, 0x1f
  ds_write_b16_d16_hi v62, v61 offset:2
  ds_write_b16 v62, v63 offset:4
  s_mov_b64 exec, -1
  s_waitcnt lgkmcnt(0)
  s_barrier
  s_endpgm
  .balignl 256, 0xbf810000
  .fill 48, 4, 0xbf810000
L_cons1:
  s_cmp_eq_u32 s26, 0
  s_cbranch_scc1 L_pad_2
  s_cmp_eq_u32 s26, 1
  s_cbranch_scc1 L_pad_3
  s_cmp_eq_u32 s26, 2
  s_cbranch_scc1 L_pad_7
  s_branch L_pad_8
L_chain_done:
  s_and_b32 s40, s27, 1
  s_lshl_b32 s96, s27, 2
  s_and_b32 s41, s28, 3
  s_add_u32 s96, s96, s41
  s_xor_b32 s41, s40, 1
  s_lshl_b32 s41, s41, 2
  s_bfe_u32 s42, s27, 0x20001
  s_add_u32 s41, s41, s42
  s_add_u32 s97, s27, 64
  s_cmp_lt_u32 s27, 8
  s_cselect_b32 s97, s97, 255
  s_cmp_eq_u32 s28, s41
  s_cselect_b32 s97, s97, 255
  s_lshr_b32 s41, s28, 2
  s_cmp_eq_u32 s41, s40
  s_cselect_b32 s96, s96, s97
  s_mul_i32 s97, s27, 3
  s_sub_u32 s40, s28, s97
  s_and_b32 s40, s40, 7
  s_add_u32 s97, s97, s40
  s_cmp_lt_u32 s40, 3
  s_cselect_b32 s97, s97, 255
  s_cmp_ge_u32 s28, 8
  s_cselect_b32 s97, s97, 255
  s_mul_i32 s38, s26, 32768
  v_and_b32 v20, 15, v1
  v_lshrrev_b32 v21, 4, v1
  v_and_b32 v22, 7, v20
  v_lshlrev_b32 v22, 1, v22
  v_lshlrev_b32 v23, 8, v20
  v_add_u32 v23, s38, v23
  v_add_u32 v24, 0, v21
  v_xor_b32 v24, v24, v22
  v_lshl_add_u32 v2, v24, 4, v23
  v_add_u32 v24, 4, v21
  v_xor_b32 v24, v24, v22
  v_lshl_add_u32 v3, v24, 4, v23
  v_add_u32 v24, 8, v21
  v_xor_b32 v24, v24, v22
  v_lshl_add_u32 v4, v24, 4, v23
  v_add_u32 v24, 12, v21
  v_xor_b32 v24, v24, v22
  v_lshl_add_u32 v5, v24, 4, v23
  v_lshrrev_b32 v22, 2, v20
  v_lshl_add_u32 v22, v21, 2, v22
  v_and_b32 v24, 7, v22
  v_lshlrev_b32 v23, 8, v22
  v_add_u32 v23, s38, v23
  v_and_b32 v25, 3, v20
  v_lshl_add_u32 v23, v25, 3, v23
  v_xor_b32 v25, 0, v24
  v_lshl_add_u32 v6, v25, 5, v23
  v_xor_b32 v25, 1, v24
  v_lshl_add_u32 v7, v25, 5, v23
  v_xor_b32 v25, 2, v24
  v_lshl_add_u32 v8, v25, 5, v23
  v_xor_b32 v25, 3, v24
  v_lshl_add_u32 v9, v25, 5, v23
  v_xor_b32 v25, 4, v24
  v_lshl_add_u32 v10, v25, 5, v23
  v_xor_b32 v25, 5, v24
  v_lshl_add_u32 v11, v25, 5, v23
  v_xor_b32 v25, 6, v24
  v_lshl_add_u32 v12, v25, 5, v23
  v_xor_b32 v25, 7, v24
  v_lshl_add_u32 v13, v25, 5, v23
  s_lshl_b32 s40, s26, 2
  s_add_u32 s40, s40, 151552
  v_mov_b32 v14, s40
  v_mov_b32 v32, 0
  v_mov_b32 v33, 0
  v_mov_b32 v34, 0
  v_mov_b32 v35, 0
  v_mov_b32 v36, 0
  v_mov_b32 v37, 0
  v_mov_b32 v38, 0
  v_mov_b32 v39, 0
  v_mov_b32 v40, 0
  v_mov_b32 v41, 0
  v_mov_b32 v42, 0
  v_mov_b32 v43, 0
  v_mov_b32 v44, 0
  v_mov_b32 v45, 0
  v_mov_b32 v46, 0
  v_mov_b32 v47, 0
  v_mov_b32 v48, 0
  v_mov_b32 v49, 0
  v_mov_b32 v50, 0
  v_mov_b32 v51, 0
  v_mov_b32 v52, 0
  v_mov_b32 v53, 0
  v_mov_b32 v54, 0
  v_mov_b32 v55, 0
  v_mov_b32 v56, 0
  v_mov_b32 v57, 0
  v_mov_b32 v58, 0
  v_mov_b32 v59, 0
  v_mov_b32 v60, 0
  v_mov_b32 v61, 0
  v_mov_b32 v62, 0
  v_mov_b32 v63, 0
  v_mov_b32 v100, 0xff800000
  v_mov_b32 v101, 0
  s_mov_b32 s44, 1069066811
  v_lshlrev_b32 v123, 9, v20
  v_lshl_add_u32 v123, v21, 4, v123
  s_lshl_b32 s40, s26, 10
  s_add_u32 s40, s40, 151808
  v_add_u32 v123, s40, v123
  s_lshl_b32 s40, s26, 4
  s_add_u32 s40, s40, 155904
  v_lshlrev_b32 v124, 3, v20
  v_add_u32 v124, s40, v124
  s_lshl_b32 s40, s26, 6
  v_add_u32 v122, s40, v1
  v_lshrrev_b32 v125, 3, v122
  v_lshlrev_b32 v125, 6, v125
  v_and_b32 v122, 7, v122
  v_mul_u32_u24 v122, 12, v122
  v_add_u32 v125, v125, v122
  v_add_u32 v125, 151808, v125
  s_mov_b32 s35, 0
  s_mov_b32 s39, 0
  v_and_b32 v15, 1, v20
  v_lshlrev_b32 v15, 8, v15
  v_lshl_add_u32 v15, v21, 4, v15
  v_add_u32 v15, 150784, v15
  s_and_b32 s40, s39, 0x7fffffff
  s_cmp_gt_u32 s40, s35
  s_cbranch_scc1 L_c_go_9
  s_cmp_lt_i32 s39, 0
  s_cbranch_scc1 L_c_done
  s_mov_b32 s42, 262144
L_c_poll_10:
  ds_read_b32 v102, v14
  s_waitcnt lgkmcnt(0)
  v_readfirstlane_b32 s39, v102
  s_and_b32 s40, s39, 0x7fffffff
  s_cmp_gt_u32 s40, s35
  s_cbranch_scc1 L_c_go_9
  s_cmp_lt_i32 s39, 0
  s_cbranch_scc1 L_c_done
  s_sleep 1
  s_sub_u32 s42, s42, 1
  s_cmp_lg_u32 s42, 0
  s_cbranch_scc1 L_c_poll_10
  s_branch L_c_done
L_c_go_9:
  ds_read_b128 v[64:67], v2 offset:0
  ds_read_b128 v[68:71], v3 offset:0
  ds_read_b128 v[72:75], v4 offset:0
  ds_read_b128 v[76:79], v5 offset:0
  ds_read_b64_tr_b16 v[80:81], v6 offset:4096
  ds_read_b64_tr_b16 v[82:83], v7 offset:4096
  ds_read_b64_tr_b16 v[84:85], v8 offset:4096
  ds_read_b64_tr_b16 v[86:87], v9 offset:4096
  ds_read_b64_tr_b16 v[88:89], v10 offset:4096
  ds_read_b64_tr_b16 v[90:91], v11 offset:4096
  ds_read_b64_tr_b16 v[92:93], v12 offset:4096
  ds_read_b64_tr_b16 v[94:95], v13 offset:4096
  s_add_u32 s35, s35, 1
  v_mov_b32 v102, s35
  s_waitcnt lgkmcnt(0)
  s_mov_b64 exec, 1
  ds_write_b32 v14, v102 offset:16
  s_mov_b64 exec, -1
  s_and_b32 s40, s39, 0x7fffffff
  s_cmp_gt_u32 s40, s35
  s_cbranch_scc1 L_c_go_11
  s_cmp_lt_i32 s39, 0
  s_cbranch_scc1 L_c_done
  s_mov_b32 s42, 262144
L_c_poll_12:
  ds_read_b32 v102, v14
  s_waitcnt lgkmcnt(0)
  v_readfirstlane_b32 s39, v102
  s_and_b32 s40, s39, 0x7fffffff
  s_cmp_gt_u32 s40, s35
  s_cbranch_scc1 L_c_go_11
  s_cmp_lt_i32 s39, 0
  s_cbranch_scc1 L_c_done
  s_sleep 1
  s_sub_u32 s42, s42, 1
  s_cmp_lg_u32 s42, 0
  s_cbranch_scc1 L_c_poll_12
  s_branch L_c_done
L_c_go_11:
  ds_read_b128 v[128:131], v2 offset:8192
  ds_read_b128 v[132:135], v3 offset:8192
  ds_read_b128 v[136:139], v4 offset:8192
  ds_read_b128 v[140:143], v5 offset:8192
  ds_read_b64_tr_b16 v[144:145], v6 offset:12288
  ds_read_b64_tr_b16 v[146:147], v7 offset:12288
  ds_read_b64_tr_b16 v[148:149], v8 offset:12288
  ds_read_b64_tr_b16 v[150:151], v9 offset:12288
  ds_read_b64_tr_b16 v[152:153], v10 offset:12288
  ds_read_b64_tr_b16 v[154:155], v11 offset:12288
  ds_read_b64_tr_b16 v[156:157], v12 offset:12288
  ds_read_b64_tr_b16 v[158:159], v13 offset:12288
  s_add_u32 s35, s35, 1
  v_mov_b32 v102, s35
  s_waitcnt lgkmcnt(0)
  s_mov_b64 exec, 1
  ds_write_b32 v14, v102 offset:16
  s_mov_b64 exec, -1
  v_mov_b32 v102, 151552
  s_mov_b32 s42, 262144
L_c_qwait:
  ds_read_b32 v104, v102 offset:32
  s_waitcnt lgkmcnt(0)
  v_readfirstlane_b32 s40, v104
  s_cmp_lg_u32 s40, 0
  s_cbranch_scc1 L_c_qok
  s_sleep 2
  s_sub_u32 s42, s42, 1
  s_cmp_lg_u32 s42, 0
  s_cbranch_scc1 L_c_qwait
L_c_qok:
  ds_read_b128 v[16:19], v15 offset:0
  ds_read_b128 v[20:23], v15 offset:64
  ds_read_b128 v[24:27], v15 offset:128
  ds_read_b128 v[28:31], v15 offset:192
  s_waitcnt lgkmcnt(0)
  v_mfma_f32_16x16x32_bf16 v[96:99], v[64:67], v[16:19], 0
  v_mfma_f32_16x16x32_bf16 v[96:99], v[68:71], v[20:23], v[96:99]
  v_mfma_f32_16x16x32_bf16 v[96:99], v[72:75], v[24:27], v[96:99]
  v_mfma_f32_16x16x32_bf16 v[96:99], v[76:79], v[28:31], v[96:99]
  s_nop 7
  v_cvt_pk_bf16_f32 v102, v96, v97
  v_cvt_pk_bf16_f32 v103, v98, v99
  v_lshlrev_b32 v104, 16, v102
  v_and_b32 v105, 0xffff0000, v102
  v_lshlrev_b32 v106, 16, v103
  v_and_b32 v107, 0xffff0000, v103
  v_mul_f32 v104, 0x3db504f3, v104
  v_mul_f32 v105, 0x3db504f3, v105
  v_mul_f32 v106, 0x3db504f3, v106
  s_branch L_pad_7_skip
L_pad_7:
  s_branch L_chain_done
L_pad_7_skip:
  v_mul_f32 v107, 0x3db504f3, v107
  v_cvt_pk_bf16_f32 v102, v104, v105
  v_cvt_pk_bf16_f32 v103, v106, v107
  v_lshlrev_b32 v104, 16, v102
  v_and_b32 v105, 0xffff0000, v102
  v_lshlrev_b32 v106, 16, v103
  v_and_b32 v107, 0xffff0000, v103
  v_max3_f32 v108, v104, v105, v106
  v_max_f32 v108, v108, v107
  v_mul_f32 v108, s44, v108
  v_cmp_gt_f32 vcc, v108, v100
  s_cbranch_vccz L_c_nr_13
  v_mov_b32 v109, v108
  s_nop 1
  v_permlane16_swap_b32 v108, v109
  s_nop 1
  v_max_f32 v108, v108, v109
  v_mov_b32 v109, v108
  s_nop 1
  v_permlane32_swap_b32 v108, v109
  s_nop 1
  v_max_f32 v108, v108, v109
  v_max_f32 v108, v108, v100
  v_sub_f32 v109, v100, v108
  v_exp_f32 v109, v109
  v_mov_b32 v100, v108
  v_mul_f32 v101, v101, v109
  v_mul_f32 v32, v32, v109
  v_mul_f32 v33, v33, v109
  v_mul_f32 v34, v34, v109
  v_mul_f32 v35, v35, v109
  v_mul_f32 v36, v36, v109
  v_mul_f32 v37, v37, v109
  v_mul_f32 v38, v38, v109
  v_mul_f32 v39, v39, v109
  v_mul_f32 v40, v40, v109
  v_mul_f32 v41, v41, v109
  v_mul_f32 v42, v42, v109
  v_mul_f32 v43, v43, v109
  v_mul_f32 v44, v44, v109
  v_mul_f32 v45, v45, v109
  v_mul_f32 v46, v46, v109
  v_mul_f32 v47, v47, v109
  v_mul_f32 v48, v48, v109
  v_mul_f32 v49, v49, v109
  v_mul_f32 v50, v50, v109
  v_mul_f32 v51, v51, v109
  v_mul_f32 v52, v52, v109
  v_mul_f32 v53, v53, v109
  v_mul_f32 v54, v54, v109
  v_mul_f32 v55, v55, v109
  v_mul_f32 v56, v56, v109
  v_mul_f32 v57, v57, v109
  v_mul_f32 v58, v58, v109
  v_mul_f32 v59, v59, v109
  v_mul_f32 v60, v60, v109
  v_mul_f32 v61, v61, v109
  v_mul_f32 v62, v62, v109
  v_mul_f32 v63, v63, v109
L_c_nr_13:
  v_fma_f32 v104, v104, s44, -v100
  v_fma_f32 v105, v105, s44, -v100
  v_fma_f32 v106, v106, s44, -v100
  v_fma_f32 v107, v107, s44, -v100
  v_exp_f32 v104, v104
  v_exp_f32 v105, v105
  v_exp_f32 v106, v106
  v_exp_f32 v107, v107
  s_nop 0
  v_cvt_pk_bf16_f32 v118, v104, v105
  v_cvt_pk_bf16_f32 v119, v106, v107
  v_add_f32 v104, v104, v105
  v_add_f32 v106, v106, v107
  v_add_f32 v101, v101, v104
  v_add_f32 v101, v101, v106
  v_mfma_f32_16x16x16_bf16 v[32:35], v[80:81], v[118:119], v[32:35]
  v_mfma_f32_16x16x16_bf16 v[36:39], v[82:83], v[118:119], v[36:39]
  v_mfma_f32_16x16x16_bf16 v[40:43], v[84:85], v[118:119], v[40:43]
  v_mfma_f32_16x16x16_bf16 v[44:47], v[86:87], v[118:119], v[44:47]
  v_mfma_f32_16x16x16_bf16 v[48:51], v[88:89], v[118:119], v[48:51]
  v_mfma_f32_16x16x16_bf16 v[52:55], v[90:91], v[118:119], v[52:55]
  v_mfma_f32_16x16x16_bf16 v[56:59], v[92:93], v[118:119], v[56:59]
  v_mfma_f32_16x16x16_bf16 v[60:63], v[94:95], v[118:119], v[60:63]
  v_mfma_f32_16x16x32_bf16 v[96:99], v[128:131], v[16:19], 0
  v_mfma_f32_16x16x32_bf16 v[96:99], v[132:135], v[20:23], v[96:99]
  v_mfma_f32_16x16x32_bf16 v[96:99], v[136:139], v[24:27], v[96:99]
  v_mfma_f32_16x16x32_bf16 v[96:99], v[140:143], v[28:31], v[96:99]
  s_nop 7
  v_cvt_pk_bf16_f32 v102, v96, v97
  v_cvt_pk_bf16_f32 v103, v98, v99
  v_lshlrev_b32 v104, 16, v102
  v_and_b32 v105, 0xffff0000, v102
  v_lshlrev_b32 v106, 16, v103
  v_and_b32 v107, 0xffff0000, v103
  v_mul_f32 v104, 0x3db504f3, v104
  v_mul_f32 v105, 0x3db504f3, v105
  v_mul_f32 v106, 0x3db504f3, v106
  v_mul_f32 v107, 0x3db504f3, v107
  v_cvt_pk_bf16_f32 v102, v104, v105
  v_cvt_pk_bf16_f32 v103, v106, v107
  v_lshlrev_b32 v104, 16, v102
  v_and_b32 v105, 0xffff0000, v102
  v_lshlrev_b32 v106, 16, v103
  v_and_b32 v107, 0xffff0000, v103
  v_max3_f32 v108, v104, v105, v106
  v_max_f32 v108, v108, v107
  v_mul_f32 v108, s44, v108
  v_cmp_gt_f32 vcc, v108, v100
  s_cbranch_vccz L_c_nr_14
  v_mov_b32 v109, v108
  s_nop 1
  v_permlane16_swap_b32 v108, v109
  s_nop 1
  v_max_f32 v108, v108, v109
  v_mov_b32 v109, v108
  s_nop 1
  v_permlane32_swap_b32 v108, v109
  s_nop 1
  v_max_f32 v108, v108, v109
  v_max_f32 v108, v108, v100
  v_sub_f32 v109, v100, v108
  v_exp_f32 v109, v109
  v_mov_b32 v100, v108
  v_mul_f32 v101, v101, v109
  v_mul_f32 v32, v32, v109
  v_mul_f32 v33, v33, v109
  v_mul_f32 v34, v34, v109
  v_mul_f32 v35, v35, v109
  v_mul_f32 v36, v36, v109
  v_mul_f32 v37, v37, v109
  v_mul_f32 v38, v38, v109
  v_mul_f32 v39, v39, v109
  v_mul_f32 v40, v40, v109
  v_mul_f32 v41, v41, v109
  v_mul_f32 v42, v42, v109
  v_mul_f32 v43, v43, v109
  v_mul_f32 v44, v44, v109
  v_mul_f32 v45, v45, v109
  v_mul_f32 v46, v46, v109
  v_mul_f32 v47, v47, v109
  v_mul_f32 v48, v48, v109
  v_mul_f32 v49, v49, v109
  v_mul_f32 v50, v50, v109
  v_mul_f32 v51, v51, v109
  v_mul_f32 v52, v52, v109
  v_mul_f32 v53, v53, v109
  v_mul_f32 v54, v54, v109
  v_mul_f32 v55, v55, v109
  v_mul_f32 v56, v56, v109
  v_mul_f32 v57, v57, v109
  v_mul_f32 v58, v58, v109
  v_mul_f32 v59, v59, v109
  v_mul_f32 v60, v60, v109
  v_mul_f32 v61, v61, v109
  v_mul_f32 v62, v62, v109
  v_mul_f32 v63, v63, v109
L_c_nr_14:
  v_fma_f32 v104, v104, s44, -v100
  v_fma_f32 v105, v105, s44, -v100
  v_fma_f32 v106, v106, s44, -v100
  v_fma_f32 v107, v107, s44, -v100
  v_exp_f32 v104, v104
  v_exp_f32 v105, v105
  v_exp_f32 v106, v106
  v_exp_f32 v107, v107
  s_nop 0
  v_cvt_pk_bf16_f32 v118, v104, v105
  v_cvt_pk_bf16_f32 v119, v106, v107
  v_add_f32 v104, v104, v105
  v_add_f32 v106, v106, v107
  v_add_f32 v101, v101, v104
  v_add_f32 v101, v101, v106
  v_mfma_f32_16x16x16_bf16 v[32:35], v[144:145], v[118:119], v[32:35]
  v_mfma_f32_16x16x16_bf16 v[36:39], v[146:147], v[118:119], v[36:39]
  v_mfma_f32_16x16x16_bf16 v[40:43], v[148:149], v[118:119], v[40:43]
  v_mfma_f32_16x16x16_bf16 v[44:47], v[150:151], v[118:119], v[44:47]
  v_mfma_f32_16x16x16_bf16 v[48:51], v[152:153], v[118:119], v[48:51]
  v_mfma_f32_16x16x16_bf16 v[52:55], v[154:155], v[118:119], v[52:55]
  v_mfma_f32_16x16x16_bf16 v[56:59], v[156:157], v[118:119], v[56:59]
  v_mfma_f32_16x16x16_bf16 v[60:63], v[158:159], v[118:119], v[60:63]
  s_branch L_c_u2
L_c_loop:
  s_and_b32 s40, s39, 0x7fffffff
  s_cmp_gt_u32 s40, s35
  s_cbranch_scc1 L_c_go_15
  s_cmp_lt_i32 s39, 0
  s_cbranch_scc1 L_c_done
  s_mov_b32 s42, 262144
L_c_poll_16:
  ds_read_b32 v102, v14
  s_waitcnt lgkmcnt(0)
  v_readfirstlane_b32 s39, v102
  s_and_b32 s40, s39, 0x7fffffff
  s_cmp_gt_u32 s40, s35
  s_cbranch_scc1 L_c_go_15
  s_cmp_lt_i32 s39, 0
  s_cbranch_scc1 L_c_done
  s_sleep 1
  s_sub_u32 s42, s42, 1
  s_cmp_lg_u32 s42, 0
  s_cbranch_scc1 L_c_poll_16
  s_branch L_c_done
L_c_go_15:
  ds_read_b128 v[64:67], v2 offset:0
  ds_read_b128 v[68:71], v3 offset:0
  ds_read_b128 v[72:75], v4 offset:0
  ds_read_b128 v[76:79], v5 offset:0
  ds_read_b64_tr_b16 v[80:81], v6 offset:4096
  ds_read_b64_tr_b16 v[82:83], v7 offset:4096
  ds_read_b64_tr_b16 v[84:85], v8 offset:4096
  ds_read_b64_tr_b16 v[86:87], v9 offset:4096
  ds_read_b64_tr_b16 v[88:89], v10 offset:4096
  ds_read_b64_tr_b16 v[90:91], v11 offset:4096
  ds_read_b64_tr_b16 v[92:93], v12 offset:4096
  ds_read_b64_tr_b16 v[94:95], v13 offset:4096
  s_add_u32 s35, s35, 1
  s_waitcnt lgkmcnt(8)
  v_mfma_f32_16x16x32_bf16 v[96:99], v[64:67], v[16:19], 0
  v_mfma_f32_16x16x32_bf16 v[96:99], v[68:71], v[20:23], v[96:99]
  v_mfma_f32_16x16x32_bf16 v[96:99], v[72:75], v[24:27], v[96:99]
  v_mfma_f32_16x16x32_bf16 v[96:99], v[76:79], v[28:31], v[96:99]
  v_mov_b32 v102, s35
  s_waitcnt lgkmcnt(0)
  s_mov_b64 exec, 1
  ds_write_b32 v14, v102 offset:16
  s_mov_b64 exec, -1
  s_nop 3
  v_cvt_pk_bf16_f32 v102, v96, v97
  v_cvt_pk_bf16_f32 v103, v98, v99
  v_lshlrev_b32 v104, 16, v102
  v_and_b32 v105, 0xffff0000, v102
  v_lshlrev_b32 v106, 16, v103
  v_and_b32 v107, 0xffff0000, v103
  v_mul_f32 v104, 0x3db504f3, v104
  v_mul_f32 v105, 0x3db504f3, v105
  v_mul_f32 v106, 0x3db504f3, v106
  v_mul_f32 v107, 0x3db504f3, v107
  v_cvt_pk_bf16_f32 v102, v104, v105
  v_cvt_pk_bf16_f32 v103, v106, v107
  v_lshlrev_b32 v104, 16, v102
  v_and_b32 v105, 0xffff0000, v102
  s_branch L_pad_8_skip
L_pad_8:
  s_branch L_chain_done
L_pad_8_skip:
  v_lshlrev_b32 v106, 16, v103
  v_and_b32 v107, 0xffff0000, v103
  v_max3_f32 v108, v104, v105, v106
  v_max_f32 v108, v108, v107
  v_mul_f32 v108, s44, v108
  v_cmp_gt_f32 vcc, v108, v100
  s_cbranch_vccz L_c_nr_17
  v_mov_b32 v109, v108
  s_nop 1
  v_permlane16_swap_b32 v108, v109
  s_nop 1
  v_max_f32 v108, v108, v109
  v_mov_b32 v109, v108
  s_nop 1
  v_permlane32_swap_b32 v108, v109
  s_nop 1
  v_max_f32 v108, v108, v109
  v_max_f32 v108, v108, v100
  v_sub_f32 v109, v100, v108
  v_exp_f32 v109, v109
  v_mov_b32 v100, v108
  v_mul_f32 v101, v101, v109
  v_mul_f32 v32, v32, v109
  v_mul_f32 v33, v33, v109
  v_mul_f32 v34, v34, v109
  v_mul_f32 v35, v35, v109
  v_mul_f32 v36, v36, v109
  v_mul_f32 v37, v37, v109
  v_mul_f32 v38, v38, v109
  v_mul_f32 v39, v39, v109
  v_mul_f32 v40, v40, v109
  v_mul_f32 v41, v41, v109
  v_mul_f32 v42, v42, v109
  v_mul_f32 v43, v43, v109
  v_mul_f32 v44, v44, v109
  v_mul_f32 v45, v45, v109
  v_mul_f32 v46, v46, v109
  v_mul_f32 v47, v47, v109
  v_mul_f32 v48, v48, v109
  v_mul_f32 v49, v49, v109
  v_mul_f32 v50, v50, v109
  v_mul_f32 v51, v51, v109
  v_mul_f32 v52, v52, v109
  v_mul_f32 v53, v53, v109
  v_mul_f32 v54, v54, v109
  v_mul_f32 v55, v55, v109
  v_mul_f32 v56, v56, v109
  v_mul_f32 v57, v57, v109
  v_mul_f32 v58, v58, v109
  v_mul_f32 v59, v59, v109
  v_mul_f32 v60, v60, v109
  v_mul_f32 v61, v61, v109
  v_mul_f32 v62, v62, v109
  v_mul_f32 v63, v63, v109
L_c_nr_17:
  v_fma_f32 v104, v104, s44, -v100
  v_fma_f32 v105, v105, s44, -v100
  v_fma_f32 v106, v106, s44, -v100
  v_fma_f32 v107, v107, s44, -v100
  v_exp_f32 v104, v104
  v_exp_f32 v105, v105
  v_exp_f32 v106, v106
  v_exp_f32 v107, v107
  s_nop 0
  v_cvt_pk_bf16_f32 v118, v104, v105
  v_cvt_pk_bf16_f32 v119, v106, v107
  v_add_f32 v104, v104, v105
  v_add_f32 v106, v106, v107
  v_add_f32 v101, v101, v104
  v_add_f32 v101, v101, v106
  v_mfma_f32_16x16x16_bf16 v[32:35], v[80:81], v[118:119], v[32:35]
  v_mfma_f32_16x16x16_bf16 v[36:39], v[82:83], v[118:119], v[36:39]
  v_mfma_f32_16x16x16_bf16 v[40:43], v[84:85], v[118:119], v[40:43]
  v_mfma_f32_16x16x16_bf16 v[44:47], v[86:87], v[118:119], v[44:47]
  v_mfma_f32_16x16x16_bf16 v[48:51], v[88:89], v[118:119], v[48:51]
  v_mfma_f32_16x16x16_bf16 v[52:55], v[90:91], v[118:119], v[52:55]
  v_mfma_f32_16x16x16_bf16 v[56:59], v[92:93], v[118:119], v[56:59]
  v_mfma_f32_16x16x16_bf16 v[60:63], v[94:95], v[118:119], v[60:63]
  s_and_b32 s40, s39, 0x7fffffff
  s_cmp_gt_u32 s40, s35
  s_cbranch_scc1 L_c_go_18
  s_cmp_lt_i32 s39, 0
  s_cbranch_scc1 L_c_done
  s_mov_b32 s42, 262144
L_c_poll_19:
  ds_read_b32 v102, v14
  s_waitcnt lgkmcnt(0)
  v_readfirstlane_b32 s39, v102
  s_and_b32 s40, s39, 0x7fffffff
  s_cmp_gt_u32 s40, s35
  s_cbranch_scc1 L_c_go_18
  s_cmp_lt_i32 s39, 0
  s_cbranch_scc1 L_c_done
  s_sleep 1
  s_sub_u32 s42, s42, 1
  s_cmp_lg_u32 s42, 0
  s_cbranch_scc1 L_c_poll_19
  s_branch L_c_done
L_c_go_18:
  ds_read_b128 v[64:67], v2 offset:8192
  ds_read_b128 v[68:71], v3 offset:8192
  ds_read_b128 v[72:75], v4 offset:8192
  ds_read_b128 v[76:79], v5 offset:8192
  ds_read_b64_tr_b16 v[80:81], v6 offset:12288
  ds_read_b64_tr_b16 v[82:83], v7 offset:12288
  ds_read_b64_tr_b16 v[84:85], v8 offset:12288
  ds_read_b64_tr_b16 v[86:87], v9 offset:12288
  ds_read_b64_tr_b16 v[88:89], v10 offset:12288
  ds_read_b64_tr_b16 v[90:91], v11 offset:12288
  ds_read_b64_tr_b16 v[92:93], v12 offset:12288
  ds_read_b64_tr_b16 v[94:95], v13 offset:12288
  s_add_u32 s35, s35, 1
  s_waitcnt lgkmcnt(8)
  v_mfma_f32_16x16x32_bf16 v[96:99], v[64:67], v[16:19], 0
  v_mfma_f32_16x16x32_bf16 v[96:99], v[68:71], v[20:23], v[96:99]
  v_mfma_f32_16x16x32_bf16 v[96:99], v[72:75], v[24:27], v[96:99]
  v_mfma_f32_16x16x32_bf16 v[96:99], v[76:79], v[28:31], v[96:99]
  v_mov_b32 v102, s35
  s_waitcnt lgkmcnt(0)
  s_mov_b64 exec, 1
  ds_write_b32 v14, v102 offset:16
  s_mov_b64 exec, -1
  s_nop 3
  v_cvt_pk_bf16_f32 v102, v96, v97
  v_cvt_pk_bf16_f32 v103, v98, v99
  v_lshlrev_b32 v104, 16, v102
  v_and_b32 v105, 0xffff0000, v102
  v_lshlrev_b32 v106, 16, v103
  v_and_b32 v107, 0xffff0000, v103
  v_mul_f32 v104, 0x3db504f3, v104
  v_mul_f32 v105, 0x3db504f3, v105
  v_mul_f32 v106, 0x3db504f3, v106
  v_mul_f32 v107, 0x3db504f3, v107
  v_cvt_pk_bf16_f32 v102, v104, v105
  v_cvt_pk_bf16_f32 v103, v106, v107
  v_lshlrev_b32 v104, 16, v102
  v_and_b32 v105, 0xffff0000, v102
  v_lshlrev_b32 v106, 16, v103
  v_and_b32 v107, 0xffff0000, v103
  v_max3_f32 v108, v104, v105, v106
  v_max_f32 v108, v108, v107
  v_mul_f32 v108, s44, v108
  v_cmp_gt_f32 vcc, v108, v100
  s_cbranch_vccz L_c_nr_20
  v_mov_b32 v109, v108
  s_nop 1
  v_permlane16_swap_b32 v108, v109
  s_nop 1
  v_max_f32 v108, v108, v109
  v_mov_b32 v109, v108
  s_nop 1
  v_permlane32_swap_b32 v108, v109
  s_nop 1
  v_max_f32 v108, v108, v109
  v_max_f32 v108, v108, v100
  v_sub_f32 v109, v100, v108
  v_exp_f32 v109, v109
  v_mov_b32 v100, v108
  v_mul_f32 v101, v101, v109
  v_mul_f32 v32, v32, v109
  v_mul_f32 v33, v33, v109
  v_mul_f32 v34, v34, v109
  v_mul_f32 v35, v35, v109
  v_mul_f32 v36, v36, v109
  v_mul_f32 v37, v37, v109
  v_mul_f32 v38, v38, v109
  v_mul_f32 v39, v39, v109
  v_mul_f32 v40, v40, v109
  v_mul_f32 v41, v41, v109
  v_mul_f32 v42, v42, v109
  v_mul_f32 v43, v43, v109
  v_mul_f32 v44, v44, v109
  v_mul_f32 v45, v45, v109
  v_mul_f32 v46, v46, v109
  v_mul_f32 v47, v47, v109
  v_mul_f32 v48, v48, v109
  v_mul_f32 v49, v49, v109
  v_mul_f32 v50, v50, v109
  v_mul_f32 v51, v51, v109
  v_mul_f32 v52, v52, v109
  v_mul_f32 v53, v53, v109
  v_mul_f32 v54, v54, v109
  v_mul_f32 v55, v55, v109
  v_mul_f32 v56, v56, v109
  v_mul_f32 v57, v57, v109
  v_mul_f32 v58, v58, v109
  v_mul_f32 v59, v59, v109
  v_mul_f32 v60, v60, v109
  v_mul_f32 v61, v61, v109
  v_mul_f32 v62, v62, v109
  v_mul_f32 v63, v63, v109
L_c_nr_20:
  v_fma_f32 v104, v104, s44, -v100
  v_fma_f32 v105, v105, s44, -v100
  v_fma_f32 v106, v106, s44, -v100
  v_fma_f32 v107, v107, s44, -v100
  v_exp_f32 v104, v104
  v_exp_f32 v105, v105
  v_exp_f32 v106, v106
  v_exp_f32 v107, v107
  s_nop 0
  v_cvt_pk_bf16_f32 v118, v104, v105
  v_cvt_pk_bf16_f32 v119, v106, v107
  v_add_f32 v104, v104, v105
  v_add_f32 v106, v106, v107
  v_add_f32 v101, v101, v104
  v_add_f32 v101, v101, v106
  v_mfma_f32_16x16x16_bf16 v[32:35], v[80:81], v[118:119], v[32:35]
  v_mfma_f32_16x16x16_bf16 v[36:39], v[82:83], v[118:119], v[36:39]
  v_mfma_f32_16x16x16_bf16 v[40:43], v[84:85], v[118:119], v[40:43]
  v_mfma_f32_16x16x16_bf16 v[44:47], v[86:87], v[118:119], v[44:47]
  v_mfma_f32_16x16x16_bf16 v[48:51], v[88:89], v[118:119], v[48:51]
  v_mfma_f32_16x16x16_bf16 v[52:55], v[90:91], v[118:119], v[52:55]
  v_mfma_f32_16x16x16_bf16 v[56:59], v[92:93], v[118:119], v[56:59]
  v_mfma_f32_16x16x16_bf16 v[60:63], v[94:95], v[118:119], v[60:63]
L_c_u2:
  s_and_b32 s40, s39, 0x7fffffff
  s_cmp_gt_u32 s40, s35
  s_cbranch_scc1 L_c_go_21
  s_cmp_lt_i32 s39, 0
  s_cbranch_scc1 L_c_done
  s_mov_b32 s42, 262144
L_c_poll_22:
  ds_read_b32 v102, v14
  s_waitcnt lgkmcnt(0)
  v_readfirstlane_b32 s39, v102
  s_and_b32 s40, s39, 0x7fffffff
  s_cmp_gt_u32 s40, s35
  s_cbranch_scc1 L_c_go_21
  s_cmp_lt_i32 s39, 0
  s_cbranch_scc1 L_c_done
  s_sleep 1
  s_sub_u32 s42, s42, 1
  s_cmp_lg_u32 s42, 0
  s_cbranch_scc1 L_c_poll_22
  s_branch L_c_done
L_c_go_21:
  ds_read_b128 v[64:67], v2 offset:16384
  ds_read_b128 v[68:71], v3 offset:16384
  ds_read_b128 v[72:75], v4 offset:16384
  ds_read_b128 v[76:79], v5 offset:16384
  ds_read_b64_tr_b16 v[80:81], v6 offset:20480
  ds_read_b64_tr_b16 v[82:83], v7 offset:20480
  ds_read_b64_tr_b16 v[84:85], v8 offset:20480
  ds_read_b64_tr_b16 v[86:87], v9 offset:20480
  ds_read_b64_tr_b16 v[88:89], v10 offset:20480
  ds_read_b64_tr_b16 v[90:91], v11 offset:20480
  s_branch L_pad_9_skip
L_pad_9:
  s_branch L_chain_done
L_pad_9_skip:
  ds_read_b64_tr_b16 v[92:93], v12 offset:20480
  ds_read_b64_tr_b16 v[94:95], v13 offset:20480
  s_add_u32 s35, s35, 1
  s_waitcnt lgkmcnt(8)
  v_mfma_f32_16x16x32_bf16 v[96:99], v[64:67], v[16:19], 0
  v_mfma_f32_16x16x32_bf16 v[96:99], v[68:71], v[20:23], v[96:99]
  v_mfma_f32_16x16x32_bf16 v[96:99], v[72:75], v[24:27], v[96:99]
  v_mfma_f32_16x16x32_bf16 v[96:99], v[76:79], v[28:31], v[96:99]
  v_mov_b32 v102, s35
  s_waitcnt lgkmcnt(0)
  s_mov_b64 exec, 1
  ds_write_b32 v14, v102 offset:16
  s_mov_b64 exec, -1
  s_nop 3
  v_cvt_pk_bf16_f32 v102, v96, v97
  v_cvt_pk_bf16_f32 v103, v98, v99
  v_lshlrev_b32 v104, 16, v102
  v_and_b32 v105, 0xffff0000, v102
  v_lshlrev_b32 v106, 16, v103
  v_and_b32 v107, 0xffff0000, v103
  v_mul_f32 v104, 0x3db504f3, v104
  v_mul_f32 v105, 0x3db504f3, v105
  v_mul_f32 v106, 0x3db504f3, v106
  v_mul_f32 v107, 0x3db504f3, v107
  v_cvt_pk_bf16_f32 v102, v104, v105
  v_cvt_pk_bf16_f32 v103, v106, v107
  v_lshlrev_b32 v104, 16, v102
  v_and_b32 v105, 0xffff0000, v102
  v_lshlrev_b32 v106, 16, v103
  v_and_b32 v107, 0xffff0000, v103
  v_max3_f32 v108, v104, v105, v106
  v_max_f32 v108, v108, v107
  v_mul_f32 v108, s44, v108
  v_cmp_gt_f32 vcc, v108, v100
  s_cbranch_vccz L_c_nr_23
  v_mov_b32 v109, v108
  s_nop 1
  v_permlane16_swap_b32 v108, v109
  s_nop 1
  v_max_f32 v108, v108, v109
  v_mov_b32 v109, v108
  s_nop 1
  v_permlane32_swap_b32 v108, v109
  s_nop 1
  v_max_f32 v108, v108, v109
  v_max_f32 v108, v108, v100
  v_sub_f32 v109, v100, v108
  v_exp_f32 v109, v109
  v_mov_b32 v100, v108
  v_mul_f32 v101, v101, v109
  v_mul_f32 v32, v32, v109
  v_mul_f32 v33, v33, v109
  v_mul_f32 v34, v34, v109
  v_mul_f32 v35, v35, v109
  v_mul_f32 v36, v36, v109
  v_mul_f32 v37, v37, v109
  v_mul_f32 v38, v38, v109
  v_mul_f32 v39, v39, v109
  v_mul_f32 v40, v40, v109
  v_mul_f32 v41, v41, v109
  v_mul_f32 v42, v42, v109
  v_mul_f32 v43, v43, v109
  v_mul_f32 v44, v44, v109
  v_mul_f32 v45, v45, v109
  v_mul_f32 v46, v46, v109
  v_mul_f32 v47, v47, v109
  v_mul_f32 v48, v48, v109
  v_mul_f32 v49, v49, v109
  v_mul_f32 v50, v50, v109
  v_mul_f32 v51, v51, v109
  v_mul_f32 v52, v52, v109
  v_mul_f32 v53, v53, v109
  v_mul_f32 v54, v54, v109
  v_mul_f32 v55, v55, v109
  v_mul_f32 v56, v56, v109
  v_mul_f32 v57, v57, v109
  v_mul_f32 v58, v58, v109
  v_mul_f32 v59, v59, v109
  v_mul_f32 v60, v60, v109
  v_mul_f32 v61, v61, v109
  v_mul_f32 v62, v62, v109
  v_mul_f32 v63, v63, v109
L_c_nr_23:
  v_fma_f32 v104, v104, s44, -v100
  v_fma_f32 v105, v105, s44, -v100
  v_fma_f32 v106, v106, s44, -v100
  v_fma_f32 v107, v107, s44, -v100
  v_exp_f32 v104, v104
  v_exp_f32 v105, v105
  v_exp_f32 v106, v106
  v_exp_f32 v107, v107
  s_nop 0
  v_cvt_pk_bf16_f32 v118, v104, v105
  v_cvt_pk_bf16_f32 v119, v106, v107
  v_add_f32 v104, v104, v105
  v_add_f32 v106, v106, v107
  v_add_f32 v101, v101, v104
  v_add_f32 v101, v101, v106
  v_mfma_f32_16x16x16_bf16 v[32:35], v[80:81], v[118:119], v[32:35]
  v_mfma_f32_16x16x16_bf16 v[36:39], v[82:83], v[118:119], v[36:39]
  v_mfma_f32_16x16x16_bf16 v[40:43], v[84:85], v[118:119], v[40:43]
  v_mfma_f32_16x16x16_bf16 v[44:47], v[86:87], v[118:119], v[44:47]
  v_mfma_f32_16x16x16_bf16 v[48:51], v[88:89], v[118:119], v[48:51]
  v_mfma_f32_16x16x16_bf16 v[52:55], v[90:91], v[118:119], v[52:55]
  v_mfma_f32_16x16x16_bf16 v[56:59], v[92:93], v[118:119], v[56:59]
  v_mfma_f32_16x16x16_bf16 v[60:63], v[94:95], v[118:119], v[60:63]
  s_and_b32 s40, s39, 0x7fffffff
  s_cmp_gt_u32 s40, s35
  s_cbranch_scc1 L_c_go_24
  s_cmp_lt_i32 s39, 0
  s_cbranch_scc1 L_c_done
  s_mov_b32 s42, 262144
L_c_poll_25:
  ds_read_b32 v102, v14
  s_waitcnt lgkmcnt(0)
  v_readfirstlane_b32 s39, v102
  s_and_b32 s40, s39, 0x7fffffff
  s_cmp_gt_u32 s40, s35
  s_cbranch_scc1 L_c_go_24
  s_cmp_lt_i32 s39, 0
  s_cbranch_scc1 L_c_done
  s_sleep 1
  s_sub_u32 s42, s42, 1
  s_cmp_lg_u32 s42, 0
  s_cbranch_scc1 L_c_poll_25
  s_branch L_c_done
L_c_go_24:
  ds_read_b128 v[64:67], v2 offset:24576
  ds_read_b128 v[68:71], v3 offset:24576
  ds_read_b128 v[72:75], v4 offset:24576
  ds_read_b128 v[76:79], v5 offset:24576
  ds_read_b64_tr_b16 v[80:81], v6 offset:28672
  ds_read_b64_tr_b16 v[82:83], v7 offset:28672
  ds_read_b64_tr_b16 v[84:85], v8 offset:28672
  ds_read_b64_tr_b16 v[86:87], v9 offset:28672
  ds_read_b64_tr_b16 v[88:89], v10 offset:28672
  ds_read_b64_tr_b16 v[90:91], v11 offset:28672
  ds_read_b64_tr_b16 v[92:93], v12 offset:28672
  ds_read_b64_tr_b16 v[94:95], v13 offset:28672
  s_add_u32 s35, s35, 1
  s_waitcnt lgkmcnt(8)
  v_mfma_f32_16x16x32_bf16 v[96:99], v[64:67], v[16:19], 0
  v_mfma_f32_16x16x32_bf16 v[96:99], v[68:71], v[20:23], v[96:99]
  v_mfma_f32_16x16x32_bf16 v[96:99], v[72:75], v[24:27], v[96:99]
  v_mfma_f32_16x16x32_bf16 v[96:99], v[76:79], v[28:31], v[96:99]
  v_mov_b32 v102, s35
  s_waitcnt lgkmcnt(0)
  s_mov_b64 exec, 1
  ds_write_b32 v14, v102 offset:16
  s_mov_b64 exec, -1
  s_nop 3
  v_cvt_pk_bf16_f32 v102, v96, v97
  v_cvt_pk_bf16_f32 v103, v98, v99
  v_lshlrev_b32 v104, 16, v102
  v_and_b32 v105, 0xffff0000, v102
  v_lshlrev_b32 v106, 16, v103
  v_and_b32 v107, 0xffff0000, v103
  v_mul_f32 v104, 0x3db504f3, v104
  v_mul_f32 v105, 0x3db504f3, v105
  v_mul_f32 v106, 0x3db504f3, v106
  v_mul_f32 v107, 0x3db504f3, v107
  v_cvt_pk_bf16_f32 v102, v104, v105
  v_cvt_pk_bf16_f32 v103, v106, v107
  v_lshlrev_b32 v104, 16, v102
  v_and_b32 v105, 0xffff0000, v102
  v_lshlrev_b32 v106, 16, v103
  v_and_b32 v107, 0xffff0000, v103
  v_max3_f32 v108, v104, v105, v106
  v_max_f32 v108, v108, v107
  v_mul_f32 v108, s44, v108
  v_cmp_gt_f32 vcc, v108, v100
  s_cbranch_vccz L_c_nr_26
  v_mov_b32 v109, v108
  s_nop 1
  v_permlane16_swap_b32 v108, v109
  s_nop 1
  v_max_f32 v108, v108, v109
  v_mov_b32 v109, v108
  s_nop 1
  v_permlane32_swap_b32 v108, v109
  s_nop 1
  v_max_f32 v108, v108, v109
  v_max_f32 v108, v108, v100
  v_sub_f32 v109, v100, v108
  v_exp_f32 v109, v109
  v_mov_b32 v100, v108
  v_mul_f32 v101, v101, v109
  v_mul_f32 v32, v32, v109
  v_mul_f32 v33, v33, v109
  v_mul_f32 v34, v34, v109
  v_mul_f32 v35, v35, v109
  v_mul_f32 v36, v36, v109
  v_mul_f32 v37, v37, v109
  v_mul_f32 v38, v38, v109
  v_mul_f32 v39, v39, v109
  v_mul_f32 v40, v40, v109
  v_mul_f32 v41, v41, v109
  v_mul_f32 v42, v42, v109
  v_mul_f32 v43, v43, v109
  v_mul_f32 v44, v44, v109
  v_mul_f32 v45, v45, v109
  v_mul_f32 v46, v46, v109
  v_mul_f32 v47, v47, v109
  v_mul_f32 v48, v48, v109
  v_mul_f32 v49, v49, v109
  v_mul_f32 v50, v50, v109
  v_mul_f32 v51, v51, v109
  v_mul_f32 v52, v52, v109
  v_mul_f32 v53, v53, v109
  v_mul_f32 v54, v54, v109
  v_mul_f32 v55, v55, v109
  v_mul_f32 v56, v56, v109
  v_mul_f32 v57, v57, v109
  v_mul_f32 v58, v58, v109
  v_mul_f32 v59, v59, v109
  v_mul_f32 v60, v60, v109
  v_mul_f32 v61, v61, v109
  v_mul_f32 v62, v62, v109
  v_mul_f32 v63, v63, v109
L_c_nr_26:
  v_fma_f32 v104, v104, s44, -v100
  v_fma_f32 v105, v105, s44, -v100
  v_fma_f32 v106, v106, s44, -v100
  v_fma_f32 v107, v107, s44, -v100
  v_exp_f32 v104, v104
  v_exp_f32 v105, v105
  v_exp_f32 v106, v106
  v_exp_f32 v107, v107
  s_nop 0
  v_cvt_pk_bf16_f32 v118, v104, v105
  v_cvt_pk_bf16_f32 v119, v106, v107
  v_add_f32 v104, v104, v105
  v_add_f32 v106, v106, v107
  v_add_f32 v101, v101, v104
  v_add_f32 v101, v101, v106
  v_mfma_f32_16x16x16_bf16 v[32:35], v[80:81], v[118:119], v[32:35]
  v_mfma_f32_16x16x16_bf16 v[36:39], v[82:83], v[118:119], v[36:39]
  v_mfma_f32_16x16x16_bf16 v[40:43], v[84:85], v[118:119], v[40:43]
  v_mfma_f32_16x16x16_bf16 v[44:47], v[86:87], v[118:119], v[44:47]
  v_mfma_f32_16x16x16_bf16 v[48:51], v[88:89], v[118:119], v[48:51]
  v_mfma_f32_16x16x16_bf16 v[52:55], v[90:91], v[118:119], v[52:55]
  v_mfma_f32_16x16x16_bf16 v[56:59], v[92:93], v[118:119], v[56:59]
  v_mfma_f32_16x16x16_bf16 v[60:63], v[94:95], v[118:119], v[60:63]
  s_branch L_c_loop
L_pad_10:
  s_branch L_pad_11
L_c_done:
  s_mov_b32 s46, 0x00030003
  s_mov_b32 s47, 0x00030003
  s_mov_b64 exec, s[46:47]
  ds_write_b128 v123, v[32:35] offset:0
  ds_write_b128 v123, v[36:39] offset:64
  ds_write_b128 v123, v[40:43] offset:128
  ds_write_b128 v123, v[44:47] offset:192
  ds_write_b128 v123, v[48:51] offset:256
  ds_write_b128 v123, v[52:55] offset:320
  ds_write_b128 v123, v[56:59] offset:384
  ds_write_b128 v123, v[60:63] offset:448
  s_mov_b64 exec, -1
  v_mov_b32 v102, v101
  s_nop 1
  v_permlane16_swap_b32 v101, v102
  s_nop 1
  v_add_f32 v101, v101, v102
  v_mov_b32 v102, v101
  s_nop 1
  v_permlane32_swap_b32 v101, v102
  s_nop 1
  v_add_f32 v101, v101, v102
  s_mov_b64 exec, 3
  ds_write_b64 v124, v[100:101]
  s_mov_b64 exec, -1
  v_mov_b32 v105, 151552
  ds_read_b32 v68, v105 offset:36
  s_lshl_b32 s51, s27, 4
  s_add_u32 s51, s51, s28
  s_waitcnt lgkmcnt(0)
  s_barrier
  v_readfirstlane_b32 s29, v68
  s_cmp_ge_u32 s26, 2
  s_cbranch_scc1 L_c_nopub
  s_lshl_b32 s45, s26, 3
  s_add_u32 s45, s45, 155904
  v_mov_b32 v104, s45
  ds_read_b64 v[70:71], v104 offset:0
  ds_read_b64 v[72:73], v104 offset:16
  ds_read_b64 v[74:75], v104 offset:32
  ds_read_b64 v[76:77], v104 offset:48
  ds_read_b32 v32, v125 offset:0
  ds_read_b32 v36, v125 offset:4
  ds_read_b32 v40, v125 offset:8
  ds_read_b32 v33, v125 offset:1024
  ds_read_b32 v37, v125 offset:1028
  ds_read_b32 v41, v125 offset:1032
  ds_read_b32 v34, v125 offset:2048
  ds_read_b32 v38, v125 offset:2052
  ds_read_b32 v42, v125 offset:2056
  ds_read_b32 v35, v125 offset:3072
  ds_read_b32 v39, v125 offset:3076
  ds_read_b32 v43, v125 offset:3080
  s_lshl_b32 s45, s51, 11
  s_add_u32 s45, s45, 524288
  s_add_u32 s48, s24, s45
  s_addc_u32 s49, s25, 0
  s_lshl_b32 s40, s26, 10
  v_lshlrev_b32 v105, 4, v1
  v_add_u32 v105, s40, v105
  s_mov_b32 s46, 0x20202020
  s_mov_b32 s47, 0x20202020
  s_waitcnt lgkmcnt(12)
  v_max3_f32 v80, v70, v72, v74
  v_max_f32 v80, v80, v76
  v_sub_f32 v82, v70, v80
  v_sub_f32 v83, v72, v80
  v_sub_f32 v84, v74, v80
  v_sub_f32 v85, v76, v80
  v_exp_f32 v82, v82
  v_exp_f32 v83, v83
  v_exp_f32 v84, v84
  v_exp_f32 v85, v85
  s_nop 0
  v_mul_f32 v81, v71, v82
  v_fmac_f32 v81, v73, v83
  v_fmac_f32 v81, v75, v84
  v_fmac_f32 v81, v77, v85
  s_waitcnt lgkmcnt(0)
  v_mul_f32 v88, v32, v82
  v_mul_f32 v89, v36, v82
  v_mul_f32 v90, v40, v82
  v_fmac_f32 v88, v33, v83
  v_fmac_f32 v89, v37, v83
  v_fmac_f32 v90, v41, v83
  v_fmac_f32 v88, v34, v84
  v_fmac_f32 v89, v38, v84
  v_fmac_f32 v90, v42, v84
  v_fmac_f32 v88, v35, v85
  v_fmac_f32 v89, v39, v85
  v_fmac_f32 v90, v43, v85
  v_cndmask_b32 v89, v89, v80, s[46:47]
  v_cndmask_b32 v90, v90, v81, s[46:47]
  v_bitop3_b32 v91, v88, v89, v90 bitop3:0x96
  v_xor_b32 v91, s29, v91
  global_store_dwordx4 v105, v[88:91], s[48:49] sc1
  s_branch L_c_pubdone
L_c_nopub:
  v_lshlrev_b32 v102, 4, v1
  s_sub_u32 s45, s26, 2
  s_mul_i32 s40, s51, 18432
  s_mul_i32 s58, s45, 9216
  s_add_u32 s40, s40, s58
  s_add_u32 s48, s12, s40
  s_addc_u32 s49, s13, 0
  s_add_u32 s58, s58, 131072
  s_add_u32 m0, s58, 0
  s_nop 0
  global_load_lds_dwordx4 v102, s[48:49] offset:0 nt
  global_load_lds_dwordx4 v102, s[48:49] offset:1024 nt
  global_load_lds_dwordx4 v102, s[48:49] offset:2048 nt
  global_load_lds_dwordx4 v102, s[48:49] offset:3072 nt
  s_add_u32 s48, s48, 4096
  s_addc_u32 s49, s49, 0
  s_add_u32 m0, s58, 4096
  s_nop 0
  global_load_lds_dwordx4 v102, s[48:49] offset:0 nt
  global_load_lds_dwordx4 v102, s[48:49] offset:1024 nt
  global_load_lds_dwordx4 v102, s[48:49] offset:2048 nt
  global_load_lds_dwordx4 v102, s[48:49] offset:3072 nt
  s_add_u32 s48, s48, 4096
  s_addc_u32 s49, s49, 0
  s_add_u32 m0, s58, 8192
  s_nop 0
  global_load_lds_dwordx4 v102, s[48:49] offset:0 nt
  s_lshl_b32 s45, s26, 2
  s_add_u32 s45, s45, 151584
  v_mov_b32 v103, s45
  v_mov_b32 v104, 1
  s_waitcnt vmcnt(0)
  s_mov_b64 exec, 1
  ds_write_b32 v103, v104
  s_mov_b64 exec, -1
L_c_pubdone:
  v_and_b32 v102, 15, v1
  v_lshrrev_b32 v103, 4, v1
  v_lshrrev_b32 v105, 2, v102
  v_and_b32 v106, 3, v102
  v_lshl_add_u32 v107, v103, 3, v105
  v_mul_u32_u24 v107, 1152, v107
  v_lshl_add_u32 v107, v106, 3, v107
  s_mul_i32 s45, s26, 288
  v_add_u32 v107, s45, v107
  v_lshl_add_u32 v105, v103, 2, v105
  v_mul_u32_u24 v105, 1152, v105
  v_lshl_add_u32 v105, v106, 3, v105
  s_add_u32 s45, s45, 131072
  v_add_u32 v105, s45, v105
  v_lshlrev_b32 v108, 4, v103
  v_add_u32 v108, 156672, v108
  v_lshlrev_b32 v104, 3, v103
  v_add_u32 v104, 156032, v104
  s_mul_i32 s50, s97, 0x5556
  s_lshr_b32 s50, s50, 18
  s_mul_i32 s58, s50, 12
  s_sub_u32 s58, s97, s58
  s_lshr_b32 s59, s58, 2
  s_and_b32 s58, s58, 3
  s_mul_i32 s50, s50, 9
  s_mul_i32 s59, s59, 3
  s_add_u32 s50, s50, s59
  s_lshl_b32 s50, s50, 4
  s_lshl_b32 s58, s58, 2
  s_add_u32 s50, s50, s58
  v_lshrrev_b32 v121, 2, v1
  v_and_b32 v122, 3, v1
  v_lshl_add_u32 v121, v121, 4, v122
  v_add_u32 v121, s50, v121
  v_lshlrev_b32 v121, 1, v121
  s_mov_b32 s52, s4
  s_mov_b32 s53, s5
  s_mov_b32 s54, 1152
  s_mov_b32 s55, 0x00020000
  buffer_load_ushort v120, v121, s[52:55], 0 offen
  s_mul_i32 s45, s26, 768
  v_lshlrev_b32 v109, 4, v1
  v_add_u32 v109, s45, v109
  v_mov_b32 v102, 151552
  s_mov_b32 s42, 262144
L_c_wowait:
  ds_read_b64 v[110:111], v102 offset:40
  s_waitcnt lgkmcnt(0)
  v_and_b32 v110, v110, v111
  s_nop 0
  v_readfirstlane_b32 s40, v110
  s_cmp_lg_u32 s40, 0
  s_cbranch_scc1 L_c_wowait_ok
  s_sleep 1
  s_sub_u32 s42, s42, 1
  s_cmp_lg_u32 s42, 0
  s_cbranch_scc1 L_c_wowait
L_c_wowait_ok:
  ds_read_b64_tr_b16 v[68:69], v105 offset:0
  ds_read_b64_tr_b16 v[70:71], v105 offset:32
  ds_read_b64_tr_b16 v[72:73], v105 offset:64
  ds_read_b64_tr_b16 v[74:75], v105 offset:96
  ds_read_b64_tr_b16 v[76:77], v105 offset:128
  ds_read_b64_tr_b16 v[78:79], v105 offset:160
  ds_read_b64_tr_b16 v[80:81], v105 offset:192
  ds_read_b64_tr_b16 v[82:83], v105 offset:224
  ds_read_b64_tr_b16 v[84:85], v105 offset:256
  v_mov_b32 v96, 0
  v_mov_b32 v97, 0
  v_mov_b32 v98, 0
  v_mov_b32 v99, 0
  s_mul_i32 s45, s51, 3072
  s_add_u32 s45, s45, 1048576
  s_add_u32 s48, s24, s45
  s_addc_u32 s49, s25, 0
  s_lshl_b32 s45, s26, 6
  v_lshrrev_b32 v10, 2, v1
  v_add_u32 v10, s45, v10
  v_mul_u32_u24 v10, 3072, v10
  v_and_b32 v11, 3, v1
  v_lshl_add_u32 v10, v11, 4, v10
  v_add_u32 v11, 49152, v10
  v_add_u32 v12, 98304, v10
  v_add_u32 v13, 147456, v10
  s_lshl_b32 s58, s97, 6
  s_add_u32 s58, s58, 1048576
  s_add_u32 s30, s24, s58
  s_addc_u32 s31, s25, 0
  s_add_u32 s45, s45, 156160
  v_lshlrev_b32 v118, 4, v1
  v_add_u32 v118, s45, v118
  s_branch L_pad_11_skip
L_pad_11:
  s_branch L_chain2_done
L_pad_11_skip:
  v_lshrrev_b32 v116, 2, v1
  v_and_b32 v117, 3, v1
  v_lshlrev_b32 v116, 2, v116
  v_lshl_add_u32 v116, v117, 4, v116
  v_add_u32 v117, 156800, v116
  v_add_u32 v116, 156160, v116
  s_waitcnt lgkmcnt(0)
  s_barrier
  ds_read_b64 v[64:65], v104
  s_mov_b32 s46, 0xffff0000
  s_mov_b32 s47, 0
  s_mov_b32 s58, 0
  s_mov_b32 s59, 0xffff
  s_waitcnt lgkmcnt(0)
  v_mfma_f32_16x16x16_bf16 v[32:35], v[64:65], v[68:69], 0
  v_mfma_f32_16x16x16_bf16 v[36:39], v[64:65], v[70:71], 0
  v_mfma_f32_16x16x16_bf16 v[40:43], v[64:65], v[72:73], 0
  v_mfma_f32_16x16x16_bf16 v[44:47], v[64:65], v[74:75], 0
  v_mfma_f32_16x16x16_bf16 v[48:51], v[64:65], v[76:77], 0
  v_mfma_f32_16x16x16_bf16 v[52:55], v[64:65], v[78:79], 0
  v_mfma_f32_16x16x16_bf16 v[56:59], v[64:65], v[80:81], 0
  v_mfma_f32_16x16x16_bf16 v[60:63], v[64:65], v[82:83], 0
  v_mfma_f32_16x16x16_bf16 v[64:67], v[64:65], v[84:85], 0
  s_nop 2
  v_cndmask_b32 v96, v32, v44, s[46:47]
  v_cndmask_b32 v97, v36, v48, s[46:47]
  v_cndmask_b32 v98, v40, v52, s[46:47]
  s_mov_b32 s46, -1
  s_mov_b32 s47, 0xffff
  v_cndmask_b32 v96, v96, v56, s[58:59]
  v_cndmask_b32 v97, v97, v60, s[58:59]
  v_cndmask_b32 v98, v98, v64, s[58:59]
  v_bitop3_b32 v99, v96, v97, v98 bitop3:0x96
  v_xor_b32 v99, s29, v99
  s_mov_b64 exec, s[46:47]
  global_store_dwordx4 v109, v[96:99], s[48:49] sc1
  s_mov_b64 exec, -1
  s_cmp_lt_u32 s97, 48
  s_cbranch_scc1 L_c_red
  s_endpgm
L_c_red:
  s_mov_b64 s[60:61], -1
  s_mov_b32 s63, 1
  s_mov_b32 s64, 262144
L_c_d_loop:
  s_mov_b64 exec, s[60:61]
  s_cmp_lg_u32 s63, 0
  s_cbranch_scc1 L_c_d_go
  s_ff1_i32_b64 s62, s[60:61]
  s_lshl_b64 exec, 1, s62
L_c_d_go:
  global_load_dwordx4 v[64:67], v10, s[30:31] sc1
  global_load_dwordx4 v[68:71], v11, s[30:31] sc1
  global_load_dwordx4 v[72:75], v12, s[30:31] sc1
  global_load_dwordx4 v[76:79], v13, s[30:31] sc1
  s_waitcnt vmcnt(0)
  v_bitop3_b32 v96, v64, v65, v66 bitop3:0x96
  v_bitop3_b32 v96, v96, v67, s29 bitop3:0x96
  v_bitop3_b32 v97, v68, v69, v70 bitop3:0x96
  v_bitop3_b32 v97, v97, v71, s29 bitop3:0x96
  v_or_b32 v96, v96, v97
  v_bitop3_b32 v97, v72, v73, v74 bitop3:0x96
  v_bitop3_b32 v97, v97, v75, s29 bitop3:0x96
  v_or_b32 v96, v96, v97
  v_bitop3_b32 v97, v76, v77, v78 bitop3:0x96
  v_bitop3_b32 v97, v97, v79, s29 bitop3:0x96
  v_or_b32 v96, v96, v97
  v_cmp_eq_u32 vcc, 0, v96
  s_andn2_b64 s[60:61], s[60:61], vcc
  s_cmp_lg_u64 vcc, 0
  s_cselect_b32 s62, 1, 0
  s_xor_b32 s63, s63, 1
  s_and_b32 s63, s63, s62
  s_mov_b64 exec, -1
  s_cmp_eq_u64 s[60:61], 0
  s_cbranch_scc1 L_c_d_done
  s_bcnt1_i32_b64 s62, s[60:61]
  s_cmp_le_u32 s62, 64
  s_cbranch_scc1 L_c_d_p2
  s_sleep 3
  s_sub_u32 s64, s64, 1
  s_cmp_lg_u32 s64, 0
  s_cbranch_scc1 L_c_d_loop
  s_branch L_c_d_done
L_c_d_p2:
  s_mov_b64 exec, s[60:61]
  global_load_dwordx4 v[64:67], v10, s[30:31] sc1
  global_load_dwordx4 v[68:71], v11, s[30:31] sc1
  global_load_dwordx4 v[72:75], v12, s[30:31] sc1
  global_load_dwordx4 v[76:79], v13, s[30:31] sc1
  s_sleep 8
  global_load_dwordx4 v[80:83], v10, s[30:31] sc1
  global_load_dwordx4 v[84:87], v11, s[30:31] sc1
  global_load_dwordx4 v[88:91], v12, s[30:31] sc1
  global_load_dwordx4 v[92:95], v13, s[30:31] sc1
L_c_d_p2l:
  s_waitcnt vmcnt(4)
  v_bitop3_b32 v96, v64, v65, v66 bitop3:0x96
  v_bitop3_b32 v96, v96, v67, s29 bitop3:0x96
  v_bitop3_b32 v97, v68, v69, v70 bitop3:0x96
  v_bitop3_b32 v97, v97, v71, s29 bitop3:0x96
  v_or_b32 v96, v96, v97
  v_bitop3_b32 v97, v72, v73, v74 bitop3:0x96
  v_bitop3_b32 v97, v97, v75, s29 bitop3:0x96
  v_or_b32 v96, v96, v97
  v_bitop3_b32 v97, v76, v77, v78 bitop3:0x96
  v_bitop3_b32 v97, v97, v79, s29 bitop3:0x96
  v_or_b32 v96, v96, v97
  v_cmp_eq_u32 vcc, 0, v96
  s_and_b64 vcc, vcc, s[60:61]
  s_andn2_b64 s[60:61], s[60:61], vcc
  s_cmp_eq_u64 s[60:61], 0
  s_cbranch_scc1 L_c_d_done
  s_mov_b64 exec, s[60:61]
  global_load_dwordx4 v[64:67], v10, s[30:31] sc1
  global_load_dwordx4 v[68:71], v11, s[30:31] sc1
  global_load_dwordx4 v[72:75], v12, s[30:31] sc1
  global_load_dwordx4 v[76:79], v13, s[30:31] sc1
  s_waitcnt vmcnt(4)
  v_bitop3_b32 v96, v80, v81, v82 bitop3:0x96
  v_bitop3_b32 v96, v96, v83, s29 bitop3:0x96
  v_bitop3_b32 v97, v84, v85, v86 bitop3:0x96
  v_bitop3_b32 v97, v97, v87, s29 bitop3:0x96
  v_or_b32 v96, v96, v97
  v_bitop3_b32 v97, v88, v89, v90 bitop3:0x96
  v_bitop3_b32 v97, v97, v91, s29 bitop3:0x96
  v_or_b32 v96, v96, v97
  v_bitop3_b32 v97, v92, v93, v94 bitop3:0x96
  v_bitop3_b32 v97, v97, v95, s29 bitop3:0x96
  v_or_b32 v96, v96, v97
  v_cmp_eq_u32 vcc, 0, v96
  s_and_b64 vcc, vcc, s[60:61]
  s_mov_b64 exec, vcc
  v_mov_b32 v64, v80
  v_mov_b32 v65, v81
  v_mov_b32 v66, v82
  v_mov_b32 v68, v84
  v_mov_b32 v69, v85
  v_mov_b32 v70, v86
  v_mov_b32 v72, v88
  v_mov_b32 v73, v89
  v_mov_b32 v74, v90
  v_mov_b32 v76, v92
  v_mov_b32 v77, v93
  v_mov_b32 v78, v94
  s_andn2_b64 s[60:61], s[60:61], vcc
  s_cmp_eq_u64 s[60:61], 0
  s_cbranch_scc1 L_c_d_done
  s_mov_b64 exec, s[60:61]
  global_load_dwordx4 v[80:83], v10, s[30:31] sc1
  global_load_dwordx4 v[84:87], v11, s[30:31] sc1
  global_load_dwordx4 v[88:91], v12, s[30:31] sc1
  global_load_dwordx4 v[92:95], v13, s[30:31] sc1
  s_sub_u32 s64, s64, 1
  s_cmp_lg_u32 s64, 0
  s_cbranch_scc1 L_c_d_p2l
L_c_d_done:
  s_mov_b64 exec, -1
  v_add_f32 v106, v64, v68
  v_add_f32 v112, v72, v76
  v_add_f32 v107, v65, v69
  v_add_f32 v113, v73, v77
  v_add_f32 v108, v66, v70
  v_add_f32 v114, v74, v78
  v_add_f32 v106, v106, v112
  v_add_f32 v107, v107, v113
  v_add_f32 v108, v108, v114
  v_add_f32_dpp v106, v106, v106 row_ror:4 row_mask:0xf bank_mask:0xf
  v_add_f32_dpp v107, v107, v107 row_ror:4 row_mask:0xf bank_mask:0xf
  v_add_f32_dpp v108, v108, v108 row_ror:4 row_mask:0xf bank_mask:0xf
  v_add_f32_dpp v106, v106, v106 row_ror:8 row_mask:0xf bank_mask:0xf
  v_add_f32_dpp v107, v107, v107 row_ror:8 row_mask:0xf bank_mask:0xf
  v_add_f32_dpp v108, v108, v108 row_ror:8 row_mask:0xf bank_mask:0xf
  v_mov_b32 v112, v106
  v_mov_b32 v113, v107
  v_mov_b32 v114, v108
  s_nop 0
  v_permlane16_swap_b32 v106, v112
  v_permlane16_swap_b32 v107, v113
  v_permlane16_swap_b32 v108, v114
  v_add_f32 v106, v106, v112
  v_add_f32 v107, v107, v113
  v_add_f32 v108, v108, v114
  v_mov_b32 v112, v106
  v_mov_b32 v113, v107
  v_mov_b32 v114, v108
  s_nop 0
  v_permlane32_swap_b32 v106, v112
  v_permlane32_swap_b32 v107, v113
  v_permlane32_swap_b32 v108, v114
  v_add_f32 v106, v106, v112
  v_add_f32 v107, v107, v113
  v_add_f32 v108, v108, v114
  s_mov_b64 exec, 15
  ds_write_b96 v118, v[106:108]
  s_mov_b64 exec, -1
  ds_read_b32 v119, v117
  s_mov_b32 s52, s20
  s_mov_b32 s53, s21
  s_waitcnt lgkmcnt(0)
  s_barrier
  s_cmp_lg_u32 s26, 0
  s_cbranch_scc1 L_end
  ds_read_b32 v100, v116 offset:0
  ds_read_b32 v101, v116 offset:64
  ds_read_b32 v102, v116 offset:128
  ds_read_b32 v103, v116 offset:192
  v_lshlrev_b32 v111, 16, v120
  s_waitcnt lgkmcnt(0)
  v_add_f32 v100, v100, v101
  v_add_f32 v102, v102, v103
  v_add_f32 v100, v100, v102
  v_cvt_pk_bf16_f32 v100, v100, v119
  v_lshlrev_b32 v101, 16, v100
  v_and_b32 v104, 0xffff0000, v100
  v_add_f32 v101, v111, v101
  v_cvt_pk_bf16_f32 v102, v101, v101
  v_lshlrev_b32 v101, 16, v102
  v_add_f32 v101, v101, v104
  v_cvt_pk_bf16_f32 v101, v101, v101
  s_mov_b64 exec, 0xfff
  buffer_store_short v101, v121, s[52:55], 0 offen
  s_mov_b64 exec, -1
  s_cmp_lg_u32 s97, 0
  s_cbranch_scc1 L_end
  v_mov_b32 v106, s29
  v_mov_b32 v107, 0
  s_mov_b64 exec, 1
  global_store_dword v107, v106, s[24:25] sc1
  s_branch L_end
L_end:
  s_endpgm
.section .rodata,"a"
.p2align 6
.amdhsa_kernel parallel_sum__gqa_block_cached__dense_activation_silu__decode_kernel
  .amdhsa_next_free_vgpr 160
  .amdhsa_next_free_sgpr 100
  .amdhsa_accum_offset 160
  .amdhsa_group_segment_fixed_size 0
  .amdhsa_kernarg_size 88
  .amdhsa_user_sgpr_count 2
  .amdhsa_user_sgpr_kernarg_segment_ptr 1
  .amdhsa_system_sgpr_workgroup_id_x 1
  .amdhsa_float_denorm_mode_32 3
  .amdhsa_float_denorm_mode_16_64 3
.end_amdhsa_kernel
```
